```python
import torch

def _softmax(x, axis=-1):
    return torch.softmax(x, dim=axis)
def _gelu(x):
    return torch.nn.functional.gelu(x, approximate="tanh")
def _silu(x):
    return torch.nn.functional.silu(x)
def _sigmoid(x):
    return torch.sigmoid(x)
def _layernorm(x, axis=-1, eps=1e-5):
    m = x.mean(dim=axis, keepdim=True)
    v = x.var(dim=axis, keepdim=True, unbiased=False)
    return (x - m) / torch.sqrt(v + eps)
def _scatter_add(tgt, idx, src, axis=0):
    return tgt.clone().index_add_(axis, idx, src)
def _segment_sum(src, seg, n):
    out = torch.zeros((n,) + src.shape[1:], dtype=src.dtype)
    return out.index_add_(0, seg, src)
def _pad(x, pw):
    flat = tuple(v for pair in reversed(pw) for v in pair)
    return torch.nn.functional.pad(x, flat)

kernel_name = 'standalone__gqa_softmax__near_ridge'

def setup_inputs():

    _w = (lambda a: (lambda t: t.to(torch.bfloat16) if t.is_floating_point() else t)(torch.as_tensor(a)))
    B, Hq, Hkv, Sq, Sk, D = 32, 32, 8, 256, 256, 128
    return {
        "q": _w((lambda *s: torch.randn(*s, dtype=torch.bfloat16) * 0.8)(B, Hq, Sq, D)),
        "k": _w((lambda *s: torch.randn(*s, dtype=torch.bfloat16) * 0.8)(B, Hkv, Sk, D)),
        "v": _w((lambda *s: torch.randn(*s, dtype=torch.bfloat16) * 0.05)(B, Hkv, Sk, D)),
    }

def reference(q, k, v):
    B, Hq, Sq, D = q.shape
    Hkv = k.shape[1]
    rep = Hq // Hkv
    k = (lambda x, n, axis: torch.repeat_interleave(x, n, dim=axis))(k, rep, axis=1)
    v = (lambda x, n, axis: torch.repeat_interleave(x, n, dim=axis))(v, rep, axis=1)
    scale = D ** -0.5
    scores = torch.einsum("bhqd,bhkd->bhqk", q, k) * scale
    p = _softmax(scores, axis=-1)
    return torch.einsum("bhqk,bhkd->bhqd", p, v)
```

```asm
; @launch grid=(256,1,1) block=(512,1,1) lds=163840
.amdgcn_target "amdgcn-amd-amdhsa--gfx950"
.text
.globl standalone__gqa_softmax__near_ridge_kernel
.p2align 8
.type standalone__gqa_softmax__near_ridge_kernel,@function
standalone__gqa_softmax__near_ridge_kernel:
  s_cmp_ge_u32 s2, 256
  s_cbranch_scc1 L_end
  s_load_dwordx4 s[4:7], s[0:1], 0
  s_load_dwordx4 s[8:11], s[0:1], 16
  v_lshrrev_b32 v1, 6, v0
  v_and_b32 v0, 63, v0
  v_readfirstlane_b32 s3, v1
  v_and_b32 v4, 15, v0
  v_lshrrev_b32 v5, 4, v0
  v_lshrrev_b32 v9, 3, v0
  v_and_b32 v10, 7, v0
  v_lshlrev_b32 v62, 8, v9
  v_lshl_add_u32 v62, v10, 4, v62
  s_lshl_b32 s34, s3, 2
  v_add_u32 v6, s34, v5
  v_and_b32 v6, 15, v6
  v_xor_b32 v6, v6, v4
  v_lshlrev_b32 v6, 4, v6
  v_lshl_add_u32 v11, v5, 8, v6
  v_lshlrev_b32 v6, 2, v5
  v_xor_b32 v6, v6, v4
  v_lshlrev_b32 v6, 4, v6
  v_lshl_add_u32 v128, v5, 8, v6
  s_lshr_b32 s42, s3, 2
  s_mul_i32 s45, s42, 99
  s_waitcnt lgkmcnt(0)
  s_mov_b32 s12, s4
  s_and_b32 s13, s5, 0xffff
  s_mov_b32 s14, 0x4000000
  s_mov_b32 s15, 0x20000
  s_mov_b32 s16, s6
  s_and_b32 s17, s7, 0xffff
  s_mov_b32 s18, 0x1000000
  s_mov_b32 s19, 0x20000
  s_mov_b32 s20, s8
  s_and_b32 s21, s9, 0xffff
  s_mov_b32 s22, 0x1000000
  s_mov_b32 s23, 0x20000
  s_mov_b32 s24, s10
  s_and_b32 s25, s11, 0xffff
  s_mov_b32 s26, 0
  s_mov_b32 s27, 0x20000
  s_mul_i32 s8, s42, -96
  s_add_u32 s8, s8, 99
  s_mul_i32 s9, s42, 3
  s_lshl_b32 s32, s2, 18
  s_lshl_b32 s29, s3, 13
  s_add_u32 s32, s32, s29
  s_add_u32 s33, s32, 0x1000
  s_lshl_b32 s30, s2, 16
  s_lshl_b32 s31, s3, 10
  s_add_u32 s30, s30, s31
  s_add_u32 m0, s31, 0
  s_add_u32 s38, s30, 0
  buffer_load_dwordx4 v11, s[16:19], s38 offen nt lds
  s_add_u32 m0, s31, 8192
  s_add_u32 s38, s30, 8192
  buffer_load_dwordx4 v11, s[16:19], s38 offen nt lds
  s_add_u32 m0, s31, 16384
  s_add_u32 s38, s30, 16384
  buffer_load_dwordx4 v11, s[16:19], s38 offen nt lds
  s_add_u32 m0, s31, 24576
  s_add_u32 s38, s30, 24576
  buffer_load_dwordx4 v11, s[16:19], s38 offen nt lds
  s_add_u32 m0, s31, 32768
  s_add_u32 s38, s30, 32768
  buffer_load_dwordx4 v11, s[16:19], s38 offen nt lds
  s_add_u32 m0, s31, 40960
  s_add_u32 s38, s30, 40960
  buffer_load_dwordx4 v11, s[16:19], s38 offen nt lds
  s_add_u32 m0, s31, 49152
  s_add_u32 s38, s30, 49152
  buffer_load_dwordx4 v11, s[16:19], s38 offen nt lds
  s_add_u32 m0, s31, 57344
  s_add_u32 s38, s30, 57344
  buffer_load_dwordx4 v11, s[16:19], s38 offen nt lds
  s_mov_b32 s34, s32
  s_mov_b32 s35, s33
  s_add_u32 s36, s32, 0x10000
  s_add_u32 s37, s33, 0x10000
  v_lshlrev_b32 v7, 8, v4
  v_xor_b32 v6, v5, v4
  v_lshl_add_u32 v244, v6, 4, v7
  v_lshlrev_b32 v7, 4, v4
  v_lshl_add_u32 v247, v5, 10, v7
  v_xor_b32 v6, v5, v10
  v_lshlrev_b32 v6, 4, v6
  v_lshl_add_u32 v246, v9, 8, v6
  s_lshl_b32 s43, s3, 12
  s_add_u32 s43, s43, 0x20000
  v_lshlrev_b32 v7, 7, v9
  v_add_u32 v7, s43, v7
  v_or_b32 v6, 0, v5
  v_xor_b32 v6, v6, v10
  v_lshl_add_u32 v60, v6, 4, v7
  v_or_b32 v6, 4, v5
  v_xor_b32 v6, v6, v10
  v_lshl_add_u32 v61, v6, 4, v7
  v_lshrrev_b32 v8, 1, v4
  v_lshlrev_b32 v7, 7, v4
  v_add_u32 v7, s43, v7
  v_xor_b32 v6, v5, v8
  v_lshl_add_u32 v245, v6, 4, v7
  v_xor_b32 v104, 64, v245
  s_mov_b32 s44, 0x3e0293ee
  s_mov_b32 s41, 0
  s_mov_b32 s46, 0x30800000
  s_mov_b32 s47, 0x4e800000
  s_mov_b32 s54, 0x20000
  s_cmp_lg_u32 s42, 0
  s_cbranch_scc1 L_p_c_1
  s_mov_b32 s54, 0x10000
  buffer_load_dwordx4 v[192:195], v62, s[12:15], s32 offen offset:0 nt
  buffer_load_dwordx4 v[196:199], v62, s[12:15], s32 offen offset:2048 nt
  buffer_load_dwordx4 v[200:203], v62, s[12:15], s33 offen offset:0 nt
  buffer_load_dwordx4 v[204:207], v62, s[12:15], s33 offen offset:2048 nt
  buffer_load_dwordx4 v[208:211], v62, s[12:15], s32 offen offset:128 nt
  buffer_load_dwordx4 v[212:215], v62, s[12:15], s32 offen offset:2176 nt
  buffer_load_dwordx4 v[216:219], v62, s[12:15], s33 offen offset:128 nt
  buffer_load_dwordx4 v[220:223], v62, s[12:15], s33 offen offset:2176 nt
  v_lshlrev_b32 v14, 4, v0
  v_add_u32 v14, s31, v14
  s_waitcnt vmcnt(15)
  ds_read_b128 v[16:19], v14 offset:0
  s_waitcnt vmcnt(14)
  ds_read_b128 v[20:23], v14 offset:8192
  s_waitcnt lgkmcnt(1)
  v_lshlrev_b32 v48, 16, v16
  v_and_b32 v49, 0xffff0000, v16
  v_lshlrev_b32 v50, 16, v17
  v_and_b32 v51, 0xffff0000, v17
  v_lshlrev_b32 v52, 16, v18
  v_and_b32 v53, 0xffff0000, v18
  v_lshlrev_b32 v54, 16, v19
  v_and_b32 v55, 0xffff0000, v19
  v_mul_f32 v48, s44, v48
  v_mul_f32 v49, s44, v49
  v_mul_f32 v50, s44, v50
  v_mul_f32 v51, s44, v51
  v_mul_f32 v52, s44, v52
  v_mul_f32 v53, s44, v53
  v_mul_f32 v54, s44, v54
  v_mul_f32 v55, s44, v55
  v_cvt_pk_bf16_f32 v16, v48, v49
  v_cvt_pk_bf16_f32 v17, v50, v51
  v_cvt_pk_bf16_f32 v18, v52, v53
  v_cvt_pk_bf16_f32 v19, v54, v55
  ds_write_b128 v14, v[16:19] offset:0
  s_waitcnt vmcnt(13)
  ds_read_b128 v[24:27], v14 offset:16384
  s_waitcnt lgkmcnt(2)
  v_lshlrev_b32 v48, 16, v20
  v_and_b32 v49, 0xffff0000, v20
  v_lshlrev_b32 v50, 16, v21
  v_and_b32 v51, 0xffff0000, v21
  v_lshlrev_b32 v52, 16, v22
  v_and_b32 v53, 0xffff0000, v22
  v_lshlrev_b32 v54, 16, v23
  v_and_b32 v55, 0xffff0000, v23
  v_mul_f32 v48, s44, v48
  v_mul_f32 v49, s44, v49
  v_mul_f32 v50, s44, v50
  v_mul_f32 v51, s44, v51
  v_mul_f32 v52, s44, v52
  v_mul_f32 v53, s44, v53
  v_mul_f32 v54, s44, v54
  v_mul_f32 v55, s44, v55
  v_cvt_pk_bf16_f32 v20, v48, v49
  v_cvt_pk_bf16_f32 v21, v50, v51
  v_cvt_pk_bf16_f32 v22, v52, v53
  v_cvt_pk_bf16_f32 v23, v54, v55
  ds_write_b128 v14, v[20:23] offset:8192
  s_waitcnt vmcnt(12)
  ds_read_b128 v[28:31], v14 offset:24576
  s_waitcnt lgkmcnt(2)
  v_lshlrev_b32 v48, 16, v24
  v_and_b32 v49, 0xffff0000, v24
  v_lshlrev_b32 v50, 16, v25
  v_and_b32 v51, 0xffff0000, v25
  v_lshlrev_b32 v52, 16, v26
  v_and_b32 v53, 0xffff0000, v26
  v_lshlrev_b32 v54, 16, v27
  v_and_b32 v55, 0xffff0000, v27
  v_mul_f32 v48, s44, v48
  v_mul_f32 v49, s44, v49
  v_mul_f32 v50, s44, v50
  v_mul_f32 v51, s44, v51
  v_mul_f32 v52, s44, v52
  v_mul_f32 v53, s44, v53
  v_mul_f32 v54, s44, v54
  v_mul_f32 v55, s44, v55
  v_cvt_pk_bf16_f32 v24, v48, v49
  v_cvt_pk_bf16_f32 v25, v50, v51
  v_cvt_pk_bf16_f32 v26, v52, v53
  v_cvt_pk_bf16_f32 v27, v54, v55
  ds_write_b128 v14, v[24:27] offset:16384
  s_waitcnt vmcnt(11)
  ds_read_b128 v[32:35], v14 offset:32768
  s_waitcnt lgkmcnt(2)
  v_lshlrev_b32 v48, 16, v28
  v_and_b32 v49, 0xffff0000, v28
  v_lshlrev_b32 v50, 16, v29
  v_and_b32 v51, 0xffff0000, v29
  v_lshlrev_b32 v52, 16, v30
  v_and_b32 v53, 0xffff0000, v30
  v_lshlrev_b32 v54, 16, v31
  v_and_b32 v55, 0xffff0000, v31
  v_mul_f32 v48, s44, v48
  v_mul_f32 v49, s44, v49
  v_mul_f32 v50, s44, v50
  v_mul_f32 v51, s44, v51
  v_mul_f32 v52, s44, v52
  v_mul_f32 v53, s44, v53
  v_mul_f32 v54, s44, v54
  v_mul_f32 v55, s44, v55
  v_cvt_pk_bf16_f32 v28, v48, v49
  v_cvt_pk_bf16_f32 v29, v50, v51
  v_cvt_pk_bf16_f32 v30, v52, v53
  v_cvt_pk_bf16_f32 v31, v54, v55
  ds_write_b128 v14, v[28:31] offset:24576
  s_waitcnt vmcnt(10)
  ds_read_b128 v[36:39], v14 offset:40960
  s_waitcnt lgkmcnt(2)
  v_lshlrev_b32 v48, 16, v32
  v_and_b32 v49, 0xffff0000, v32
  v_lshlrev_b32 v50, 16, v33
  v_and_b32 v51, 0xffff0000, v33
  v_lshlrev_b32 v52, 16, v34
  v_and_b32 v53, 0xffff0000, v34
  v_lshlrev_b32 v54, 16, v35
  v_and_b32 v55, 0xffff0000, v35
  v_mul_f32 v48, s44, v48
  v_mul_f32 v49, s44, v49
  v_mul_f32 v50, s44, v50
  v_mul_f32 v51, s44, v51
  v_mul_f32 v52, s44, v52
  v_mul_f32 v53, s44, v53
  v_mul_f32 v54, s44, v54
  v_mul_f32 v55, s44, v55
  v_cvt_pk_bf16_f32 v32, v48, v49
  v_cvt_pk_bf16_f32 v33, v50, v51
  v_cvt_pk_bf16_f32 v34, v52, v53
  v_cvt_pk_bf16_f32 v35, v54, v55
  ds_write_b128 v14, v[32:35] offset:32768
  s_waitcnt vmcnt(9)
  ds_read_b128 v[40:43], v14 offset:49152
  s_waitcnt lgkmcnt(2)
  v_lshlrev_b32 v48, 16, v36
  v_and_b32 v49, 0xffff0000, v36
  v_lshlrev_b32 v50, 16, v37
  v_and_b32 v51, 0xffff0000, v37
  v_lshlrev_b32 v52, 16, v38
  v_and_b32 v53, 0xffff0000, v38
  v_lshlrev_b32 v54, 16, v39
  v_and_b32 v55, 0xffff0000, v39
  v_mul_f32 v48, s44, v48
  v_mul_f32 v49, s44, v49
  v_mul_f32 v50, s44, v50
  v_mul_f32 v51, s44, v51
  v_mul_f32 v52, s44, v52
  v_mul_f32 v53, s44, v53
  v_mul_f32 v54, s44, v54
  v_mul_f32 v55, s44, v55
  v_cvt_pk_bf16_f32 v36, v48, v49
  v_cvt_pk_bf16_f32 v37, v50, v51
  v_cvt_pk_bf16_f32 v38, v52, v53
  v_cvt_pk_bf16_f32 v39, v54, v55
  ds_write_b128 v14, v[36:39] offset:40960
  s_waitcnt vmcnt(8)
  ds_read_b128 v[44:47], v14 offset:57344
  s_waitcnt lgkmcnt(2)
  v_lshlrev_b32 v48, 16, v40
  v_and_b32 v49, 0xffff0000, v40
  v_lshlrev_b32 v50, 16, v41
  v_and_b32 v51, 0xffff0000, v41
  v_lshlrev_b32 v52, 16, v42
  v_and_b32 v53, 0xffff0000, v42
  v_lshlrev_b32 v54, 16, v43
  v_and_b32 v55, 0xffff0000, v43
  v_mul_f32 v48, s44, v48
  v_mul_f32 v49, s44, v49
  v_mul_f32 v50, s44, v50
  v_mul_f32 v51, s44, v51
  v_mul_f32 v52, s44, v52
  v_mul_f32 v53, s44, v53
  v_mul_f32 v54, s44, v54
  v_mul_f32 v55, s44, v55
  v_cvt_pk_bf16_f32 v40, v48, v49
  v_cvt_pk_bf16_f32 v41, v50, v51
  v_cvt_pk_bf16_f32 v42, v52, v53
  v_cvt_pk_bf16_f32 v43, v54, v55
  ds_write_b128 v14, v[40:43] offset:49152
  s_waitcnt lgkmcnt(1)
  v_lshlrev_b32 v48, 16, v44
  v_and_b32 v49, 0xffff0000, v44
  v_lshlrev_b32 v50, 16, v45
  v_and_b32 v51, 0xffff0000, v45
  v_lshlrev_b32 v52, 16, v46
  v_and_b32 v53, 0xffff0000, v46
  v_lshlrev_b32 v54, 16, v47
  v_and_b32 v55, 0xffff0000, v47
  v_mul_f32 v48, s44, v48
  v_mul_f32 v49, s44, v49
  v_mul_f32 v50, s44, v50
  v_mul_f32 v51, s44, v51
  v_mul_f32 v52, s44, v52
  v_mul_f32 v53, s44, v53
  v_mul_f32 v54, s44, v54
  v_mul_f32 v55, s44, v55
  v_cvt_pk_bf16_f32 v44, v48, v49
  v_cvt_pk_bf16_f32 v45, v50, v51
  v_cvt_pk_bf16_f32 v46, v52, v53
  v_cvt_pk_bf16_f32 v47, v54, v55
  ds_write_b128 v14, v[44:47] offset:57344
  s_waitcnt lgkmcnt(0)
  s_waitcnt vmcnt(0)
  ds_write_b128 v60, v[192:195] offset:0
  ds_write_b128 v61, v[196:199] offset:1024
  ds_write_b128 v60, v[200:203] offset:2048
  ds_write_b128 v61, v[204:207] offset:3072
  ds_read_b128 v[192:195], v245 offset:0
  ds_read_b128 v[196:199], v245 offset:2048
  ds_read_b128 v[200:203], v104 offset:0
  ds_read_b128 v[204:207], v104 offset:2048
  ds_write_b128 v60, v[208:211] offset:0
  ds_write_b128 v61, v[212:215] offset:1024
  ds_write_b128 v60, v[216:219] offset:2048
  ds_write_b128 v61, v[220:223] offset:3072
  ds_read_b128 v[208:211], v245 offset:0
  ds_read_b128 v[212:215], v245 offset:2048
  ds_read_b128 v[216:219], v104 offset:0
  ds_read_b128 v[220:223], v104 offset:2048
  s_waitcnt lgkmcnt(0)
L_p_c_1:
  s_cmp_eq_u32 s42, 0
  s_cbranch_scc1 L_p_c_2
  v_lshlrev_b32 v14, 4, v0
  v_add_u32 v14, s31, v14
  s_waitcnt vmcnt(7)
  ds_read_b128 v[16:19], v14 offset:0
  s_waitcnt vmcnt(6)
  ds_read_b128 v[20:23], v14 offset:8192
  s_waitcnt lgkmcnt(1)
  v_lshlrev_b32 v48, 16, v16
  v_and_b32 v49, 0xffff0000, v16
  v_lshlrev_b32 v50, 16, v17
  v_and_b32 v51, 0xffff0000, v17
  v_lshlrev_b32 v52, 16, v18
  v_and_b32 v53, 0xffff0000, v18
  v_lshlrev_b32 v54, 16, v19
  v_and_b32 v55, 0xffff0000, v19
  v_mul_f32 v48, s44, v48
  v_mul_f32 v49, s44, v49
  v_mul_f32 v50, s44, v50
  v_mul_f32 v51, s44, v51
  v_mul_f32 v52, s44, v52
  v_mul_f32 v53, s44, v53
  v_mul_f32 v54, s44, v54
  v_mul_f32 v55, s44, v55
  v_cvt_pk_bf16_f32 v16, v48, v49
  v_cvt_pk_bf16_f32 v17, v50, v51
  v_cvt_pk_bf16_f32 v18, v52, v53
  v_cvt_pk_bf16_f32 v19, v54, v55
  ds_write_b128 v14, v[16:19] offset:0
  s_waitcnt vmcnt(5)
  buffer_load_dwordx4 v[192:195], v62, s[12:15], s32 offen offset:0 nt
  buffer_load_dwordx4 v[196:199], v62, s[12:15], s32 offen offset:2048 nt
  ds_read_b128 v[24:27], v14 offset:16384
  s_waitcnt lgkmcnt(2)
  v_lshlrev_b32 v48, 16, v20
  v_and_b32 v49, 0xffff0000, v20
  v_lshlrev_b32 v50, 16, v21
  v_and_b32 v51, 0xffff0000, v21
  v_lshlrev_b32 v52, 16, v22
  v_and_b32 v53, 0xffff0000, v22
  v_lshlrev_b32 v54, 16, v23
  v_and_b32 v55, 0xffff0000, v23
  v_mul_f32 v48, s44, v48
  v_mul_f32 v49, s44, v49
  v_mul_f32 v50, s44, v50
  v_mul_f32 v51, s44, v51
  v_mul_f32 v52, s44, v52
  v_mul_f32 v53, s44, v53
  v_mul_f32 v54, s44, v54
  v_mul_f32 v55, s44, v55
  v_cvt_pk_bf16_f32 v20, v48, v49
  v_cvt_pk_bf16_f32 v21, v50, v51
  v_cvt_pk_bf16_f32 v22, v52, v53
  v_cvt_pk_bf16_f32 v23, v54, v55
  ds_write_b128 v14, v[20:23] offset:8192
  s_waitcnt vmcnt(6)
  buffer_load_dwordx4 v[200:203], v62, s[12:15], s33 offen offset:0 nt
  buffer_load_dwordx4 v[204:207], v62, s[12:15], s33 offen offset:2048 nt
  ds_read_b128 v[28:31], v14 offset:24576
  s_waitcnt lgkmcnt(2)
  v_lshlrev_b32 v48, 16, v24
  v_and_b32 v49, 0xffff0000, v24
  v_lshlrev_b32 v50, 16, v25
  v_and_b32 v51, 0xffff0000, v25
  v_lshlrev_b32 v52, 16, v26
  v_and_b32 v53, 0xffff0000, v26
  v_lshlrev_b32 v54, 16, v27
  v_and_b32 v55, 0xffff0000, v27
  v_mul_f32 v48, s44, v48
  v_mul_f32 v49, s44, v49
  v_mul_f32 v50, s44, v50
  v_mul_f32 v51, s44, v51
  v_mul_f32 v52, s44, v52
  v_mul_f32 v53, s44, v53
  v_mul_f32 v54, s44, v54
  v_mul_f32 v55, s44, v55
  v_cvt_pk_bf16_f32 v24, v48, v49
  v_cvt_pk_bf16_f32 v25, v50, v51
  v_cvt_pk_bf16_f32 v26, v52, v53
  v_cvt_pk_bf16_f32 v27, v54, v55
  ds_write_b128 v14, v[24:27] offset:16384
  s_waitcnt vmcnt(7)
  buffer_load_dwordx4 v[208:211], v62, s[12:15], s32 offen offset:128 nt
  buffer_load_dwordx4 v[212:215], v62, s[12:15], s32 offen offset:2176 nt
  ds_read_b128 v[32:35], v14 offset:32768
  s_waitcnt lgkmcnt(2)
  v_lshlrev_b32 v48, 16, v28
  v_and_b32 v49, 0xffff0000, v28
  v_lshlrev_b32 v50, 16, v29
  v_and_b32 v51, 0xffff0000, v29
  v_lshlrev_b32 v52, 16, v30
  v_and_b32 v53, 0xffff0000, v30
  v_lshlrev_b32 v54, 16, v31
  v_and_b32 v55, 0xffff0000, v31
  v_mul_f32 v48, s44, v48
  v_mul_f32 v49, s44, v49
  v_mul_f32 v50, s44, v50
  v_mul_f32 v51, s44, v51
  v_mul_f32 v52, s44, v52
  v_mul_f32 v53, s44, v53
  v_mul_f32 v54, s44, v54
  v_mul_f32 v55, s44, v55
  v_cvt_pk_bf16_f32 v28, v48, v49
  v_cvt_pk_bf16_f32 v29, v50, v51
  v_cvt_pk_bf16_f32 v30, v52, v53
  v_cvt_pk_bf16_f32 v31, v54, v55
  ds_write_b128 v14, v[28:31] offset:24576
  s_waitcnt vmcnt(8)
  buffer_load_dwordx4 v[216:219], v62, s[12:15], s33 offen offset:128 nt
  buffer_load_dwordx4 v[220:223], v62, s[12:15], s33 offen offset:2176 nt
  ds_read_b128 v[36:39], v14 offset:40960
  s_waitcnt lgkmcnt(2)
  v_lshlrev_b32 v48, 16, v32
  v_and_b32 v49, 0xffff0000, v32
  v_lshlrev_b32 v50, 16, v33
  v_and_b32 v51, 0xffff0000, v33
  v_lshlrev_b32 v52, 16, v34
  v_and_b32 v53, 0xffff0000, v34
  v_lshlrev_b32 v54, 16, v35
  v_and_b32 v55, 0xffff0000, v35
  v_mul_f32 v48, s44, v48
  v_mul_f32 v49, s44, v49
  v_mul_f32 v50, s44, v50
  v_mul_f32 v51, s44, v51
  v_mul_f32 v52, s44, v52
  v_mul_f32 v53, s44, v53
  v_mul_f32 v54, s44, v54
  v_mul_f32 v55, s44, v55
  v_cvt_pk_bf16_f32 v32, v48, v49
  v_cvt_pk_bf16_f32 v33, v50, v51
  v_cvt_pk_bf16_f32 v34, v52, v53
  v_cvt_pk_bf16_f32 v35, v54, v55
  ds_write_b128 v14, v[32:35] offset:32768
  s_waitcnt vmcnt(9)
  ds_read_b128 v[40:43], v14 offset:49152
  s_waitcnt lgkmcnt(2)
  v_lshlrev_b32 v48, 16, v36
  v_and_b32 v49, 0xffff0000, v36
  v_lshlrev_b32 v50, 16, v37
  v_and_b32 v51, 0xffff0000, v37
  v_lshlrev_b32 v52, 16, v38
  v_and_b32 v53, 0xffff0000, v38
  v_lshlrev_b32 v54, 16, v39
  v_and_b32 v55, 0xffff0000, v39
  v_mul_f32 v48, s44, v48
  v_mul_f32 v49, s44, v49
  v_mul_f32 v50, s44, v50
  v_mul_f32 v51, s44, v51
  v_mul_f32 v52, s44, v52
  v_mul_f32 v53, s44, v53
  v_mul_f32 v54, s44, v54
  v_mul_f32 v55, s44, v55
  v_cvt_pk_bf16_f32 v36, v48, v49
  v_cvt_pk_bf16_f32 v37, v50, v51
  v_cvt_pk_bf16_f32 v38, v52, v53
  v_cvt_pk_bf16_f32 v39, v54, v55
  ds_write_b128 v14, v[36:39] offset:40960
  s_waitcnt vmcnt(8)
  ds_read_b128 v[44:47], v14 offset:57344
  s_waitcnt lgkmcnt(2)
  v_lshlrev_b32 v48, 16, v40
  v_and_b32 v49, 0xffff0000, v40
  v_lshlrev_b32 v50, 16, v41
  v_and_b32 v51, 0xffff0000, v41
  v_lshlrev_b32 v52, 16, v42
  v_and_b32 v53, 0xffff0000, v42
  v_lshlrev_b32 v54, 16, v43
  v_and_b32 v55, 0xffff0000, v43
  v_mul_f32 v48, s44, v48
  v_mul_f32 v49, s44, v49
  v_mul_f32 v50, s44, v50
  v_mul_f32 v51, s44, v51
  v_mul_f32 v52, s44, v52
  v_mul_f32 v53, s44, v53
  v_mul_f32 v54, s44, v54
  v_mul_f32 v55, s44, v55
  v_cvt_pk_bf16_f32 v40, v48, v49
  v_cvt_pk_bf16_f32 v41, v50, v51
  v_cvt_pk_bf16_f32 v42, v52, v53
  v_cvt_pk_bf16_f32 v43, v54, v55
  ds_write_b128 v14, v[40:43] offset:49152
  s_waitcnt lgkmcnt(1)
  v_lshlrev_b32 v48, 16, v44
  v_and_b32 v49, 0xffff0000, v44
  v_lshlrev_b32 v50, 16, v45
  v_and_b32 v51, 0xffff0000, v45
  v_lshlrev_b32 v52, 16, v46
  v_and_b32 v53, 0xffff0000, v46
  v_lshlrev_b32 v54, 16, v47
  v_and_b32 v55, 0xffff0000, v47
  v_mul_f32 v48, s44, v48
  v_mul_f32 v49, s44, v49
  v_mul_f32 v50, s44, v50
  v_mul_f32 v51, s44, v51
  v_mul_f32 v52, s44, v52
  v_mul_f32 v53, s44, v53
  v_mul_f32 v54, s44, v54
  v_mul_f32 v55, s44, v55
  v_cvt_pk_bf16_f32 v44, v48, v49
  v_cvt_pk_bf16_f32 v45, v50, v51
  v_cvt_pk_bf16_f32 v46, v52, v53
  v_cvt_pk_bf16_f32 v47, v54, v55
  ds_write_b128 v14, v[44:47] offset:57344
  s_waitcnt lgkmcnt(0)
L_p_c_2:
  s_barrier
  s_cmp_eq_u32 s42, 0
  s_cbranch_scc1 L_p_c_3
  s_sub_u32 s28, s31, 4096
  s_sub_u32 s29, s30, 4096
  s_add_u32 m0, s28, 65536
  s_add_u32 s38, s29, 0
  buffer_load_dwordx4 v128, s[20:23], s38 offen nt lds
  s_add_u32 m0, s31, 65536
  s_add_u32 s38, s30, 0
  buffer_load_dwordx4 v128, s[20:23], s38 offen nt lds
  s_add_u32 m0, s28, 73728
  s_add_u32 s38, s29, 8192
  buffer_load_dwordx4 v128, s[20:23], s38 offen nt lds
  s_add_u32 m0, s31, 73728
  s_add_u32 s38, s30, 8192
  buffer_load_dwordx4 v128, s[20:23], s38 offen nt lds
  s_waitcnt vmcnt(4)
  ds_write_b128 v60, v[192:195] offset:0
  ds_write_b128 v61, v[196:199] offset:1024
  ds_write_b128 v60, v[200:203] offset:2048
  ds_write_b128 v61, v[204:207] offset:3072
  ds_read_b128 v[192:195], v245 offset:0
  ds_read_b128 v[196:199], v245 offset:2048
  ds_read_b128 v[200:203], v104 offset:0
  ds_read_b128 v[204:207], v104 offset:2048
  ds_write_b128 v60, v[208:211] offset:0
  ds_write_b128 v61, v[212:215] offset:1024
  ds_write_b128 v60, v[216:219] offset:2048
  ds_write_b128 v61, v[220:223] offset:3072
  ds_read_b128 v[208:211], v245 offset:0
  ds_read_b128 v[212:215], v245 offset:2048
  ds_read_b128 v[216:219], v104 offset:0
  ds_read_b128 v[220:223], v104 offset:2048
  s_waitcnt lgkmcnt(0)
  v_xor_b32 v120, 64, v244
  v_xor_b32 v121, 128, v244
  v_xor_b32 v122, 192, v244
  ds_read_b128 v[224:227], v244 offset:0
  ds_read_b128 v[228:231], v120 offset:0
  ds_read_b128 v[232:235], v121 offset:0
  ds_read_b128 v[236:239], v122 offset:0
  s_waitcnt lgkmcnt(3)
  v_mfma_f32_16x16x32_bf16 v[0:3], v[224:227], v[192:195], 0
  ds_read_b128 v[240:243], v244 offset:4096
  v_mfma_f32_16x16x32_bf16 v[4:7], v[224:227], v[196:199], 0
  s_waitcnt lgkmcnt(3)
  v_mfma_f32_16x16x32_bf16 v[0:3], v[228:231], v[200:203], v[0:3]
  ds_read_b128 v[224:227], v120 offset:4096
  v_mfma_f32_16x16x32_bf16 v[4:7], v[228:231], v[204:207], v[4:7]
  s_waitcnt lgkmcnt(3)
  v_mfma_f32_16x16x32_bf16 v[0:3], v[232:235], v[208:211], v[0:3]
  ds_read_b128 v[228:231], v121 offset:4096
  s_add_u32 m0, s28, 81920
  s_add_u32 s38, s29, 16384
  buffer_load_dwordx4 v128, s[20:23], s38 offen nt lds
  v_mfma_f32_16x16x32_bf16 v[4:7], v[232:235], v[212:215], v[4:7]
  s_waitcnt lgkmcnt(3)
  v_mfma_f32_16x16x32_bf16 v[0:3], v[236:239], v[216:219], v[0:3]
  ds_read_b128 v[232:235], v122 offset:4096
  v_mfma_f32_16x16x32_bf16 v[4:7], v[236:239], v[220:223], v[4:7]
  s_waitcnt lgkmcnt(3)
  v_mfma_f32_16x16x32_bf16 v[8:11], v[240:243], v[192:195], 0
  ds_read_b128 v[236:239], v244 offset:8192
  v_mfma_f32_16x16x32_bf16 v[12:15], v[240:243], v[196:199], 0
  s_waitcnt lgkmcnt(3)
  v_mfma_f32_16x16x32_bf16 v[8:11], v[224:227], v[200:203], v[8:11]
  ds_read_b128 v[240:243], v120 offset:8192
  v_mfma_f32_16x16x32_bf16 v[12:15], v[224:227], v[204:207], v[12:15]
  s_waitcnt lgkmcnt(3)
  v_mfma_f32_16x16x32_bf16 v[8:11], v[228:231], v[208:211], v[8:11]
  ds_read_b128 v[224:227], v121 offset:8192
  s_add_u32 m0, s31, 81920
  s_add_u32 s38, s30, 16384
  buffer_load_dwordx4 v128, s[20:23], s38 offen nt lds
  v_mfma_f32_16x16x32_bf16 v[12:15], v[228:231], v[212:215], v[12:15]
  s_waitcnt lgkmcnt(3)
  v_mfma_f32_16x16x32_bf16 v[8:11], v[232:235], v[216:219], v[8:11]
  ds_read_b128 v[228:231], v122 offset:8192
  v_mfma_f32_16x16x32_bf16 v[12:15], v[232:235], v[220:223], v[12:15]
  s_waitcnt lgkmcnt(3)
  v_mfma_f32_16x16x32_bf16 v[16:19], v[236:239], v[192:195], 0
  ds_read_b128 v[232:235], v244 offset:12288
  v_mfma_f32_16x16x32_bf16 v[20:23], v[236:239], v[196:199], 0
  s_waitcnt lgkmcnt(3)
  v_mfma_f32_16x16x32_bf16 v[16:19], v[240:243], v[200:203], v[16:19]
  ds_read_b128 v[236:239], v120 offset:12288
  v_mfma_f32_16x16x32_bf16 v[20:23], v[240:243], v[204:207], v[20:23]
  s_waitcnt lgkmcnt(3)
  v_mfma_f32_16x16x32_bf16 v[16:19], v[224:227], v[208:211], v[16:19]
  ds_read_b128 v[240:243], v121 offset:12288
  s_add_u32 m0, s28, 90112
  s_add_u32 s38, s29, 24576
  buffer_load_dwordx4 v128, s[20:23], s38 offen nt lds
  v_mfma_f32_16x16x32_bf16 v[20:23], v[224:227], v[212:215], v[20:23]
  s_waitcnt lgkmcnt(3)
  v_mfma_f32_16x16x32_bf16 v[16:19], v[228:231], v[216:219], v[16:19]
  ds_read_b128 v[224:227], v122 offset:12288
  v_mfma_f32_16x16x32_bf16 v[20:23], v[228:231], v[220:223], v[20:23]
  s_waitcnt lgkmcnt(3)
  v_mfma_f32_16x16x32_bf16 v[24:27], v[232:235], v[192:195], 0
  ds_read_b128 v[228:231], v244 offset:16384
  v_mfma_f32_16x16x32_bf16 v[28:31], v[232:235], v[196:199], 0
  s_waitcnt lgkmcnt(3)
  v_mfma_f32_16x16x32_bf16 v[24:27], v[236:239], v[200:203], v[24:27]
  ds_read_b128 v[232:235], v120 offset:16384
  v_mfma_f32_16x16x32_bf16 v[28:31], v[236:239], v[204:207], v[28:31]
  s_waitcnt lgkmcnt(3)
  v_mfma_f32_16x16x32_bf16 v[24:27], v[240:243], v[208:211], v[24:27]
  ds_read_b128 v[236:239], v121 offset:16384
  s_add_u32 m0, s31, 90112
  s_add_u32 s38, s30, 24576
  buffer_load_dwordx4 v128, s[20:23], s38 offen nt lds
  v_mfma_f32_16x16x32_bf16 v[28:31], v[240:243], v[212:215], v[28:31]
  s_waitcnt lgkmcnt(3)
  v_mfma_f32_16x16x32_bf16 v[24:27], v[224:227], v[216:219], v[24:27]
  ds_read_b128 v[240:243], v122 offset:16384
  v_mfma_f32_16x16x32_bf16 v[28:31], v[224:227], v[220:223], v[28:31]
  s_waitcnt lgkmcnt(3)
  v_mfma_f32_16x16x32_bf16 v[32:35], v[228:231], v[192:195], 0
  ds_read_b128 v[224:227], v244 offset:20480
  v_mfma_f32_16x16x32_bf16 v[36:39], v[228:231], v[196:199], 0
  s_waitcnt lgkmcnt(3)
  v_mfma_f32_16x16x32_bf16 v[32:35], v[232:235], v[200:203], v[32:35]
  ds_read_b128 v[228:231], v120 offset:20480
  v_mfma_f32_16x16x32_bf16 v[36:39], v[232:235], v[204:207], v[36:39]
  s_waitcnt lgkmcnt(3)
  v_mfma_f32_16x16x32_bf16 v[32:35], v[236:239], v[208:211], v[32:35]
  ds_read_b128 v[232:235], v121 offset:20480
  s_add_u32 m0, s28, 98304
  s_add_u32 s38, s29, 32768
  buffer_load_dwordx4 v128, s[20:23], s38 offen nt lds
  v_mfma_f32_16x16x32_bf16 v[36:39], v[236:239], v[212:215], v[36:39]
  s_waitcnt lgkmcnt(3)
  v_mfma_f32_16x16x32_bf16 v[32:35], v[240:243], v[216:219], v[32:35]
  ds_read_b128 v[236:239], v122 offset:20480
  v_mfma_f32_16x16x32_bf16 v[36:39], v[240:243], v[220:223], v[36:39]
  s_waitcnt lgkmcnt(3)
  v_mfma_f32_16x16x32_bf16 v[40:43], v[224:227], v[192:195], 0
  ds_read_b128 v[240:243], v244 offset:24576
  v_mfma_f32_16x16x32_bf16 v[44:47], v[224:227], v[196:199], 0
  s_waitcnt lgkmcnt(3)
  v_mfma_f32_16x16x32_bf16 v[40:43], v[228:231], v[200:203], v[40:43]
  ds_read_b128 v[224:227], v120 offset:24576
  v_mfma_f32_16x16x32_bf16 v[44:47], v[228:231], v[204:207], v[44:47]
  s_waitcnt lgkmcnt(3)
  v_mfma_f32_16x16x32_bf16 v[40:43], v[232:235], v[208:211], v[40:43]
  ds_read_b128 v[228:231], v121 offset:24576
  s_add_u32 m0, s31, 98304
  s_add_u32 s38, s30, 32768
  buffer_load_dwordx4 v128, s[20:23], s38 offen nt lds
  v_mfma_f32_16x16x32_bf16 v[44:47], v[232:235], v[212:215], v[44:47]
  s_waitcnt lgkmcnt(3)
  v_mfma_f32_16x16x32_bf16 v[40:43], v[236:239], v[216:219], v[40:43]
  ds_read_b128 v[232:235], v122 offset:24576
  v_mfma_f32_16x16x32_bf16 v[44:47], v[236:239], v[220:223], v[44:47]
  s_waitcnt lgkmcnt(3)
  v_mfma_f32_16x16x32_bf16 v[48:51], v[240:243], v[192:195], 0
  ds_read_b128 v[236:239], v244 offset:28672
  v_mfma_f32_16x16x32_bf16 v[52:55], v[240:243], v[196:199], 0
  s_waitcnt lgkmcnt(3)
  v_mfma_f32_16x16x32_bf16 v[48:51], v[224:227], v[200:203], v[48:51]
  ds_read_b128 v[240:243], v120 offset:28672
  v_mfma_f32_16x16x32_bf16 v[52:55], v[224:227], v[204:207], v[52:55]
  s_waitcnt lgkmcnt(3)
  v_mfma_f32_16x16x32_bf16 v[48:51], v[228:231], v[208:211], v[48:51]
  ds_read_b128 v[224:227], v121 offset:28672
  s_add_u32 m0, s28, 106496
  s_add_u32 s38, s29, 40960
  buffer_load_dwordx4 v128, s[20:23], s38 offen nt lds
  v_mfma_f32_16x16x32_bf16 v[52:55], v[228:231], v[212:215], v[52:55]
  s_waitcnt lgkmcnt(3)
  v_mfma_f32_16x16x32_bf16 v[48:51], v[232:235], v[216:219], v[48:51]
  ds_read_b128 v[228:231], v122 offset:28672
  v_mfma_f32_16x16x32_bf16 v[52:55], v[232:235], v[220:223], v[52:55]
  s_waitcnt lgkmcnt(3)
  v_mfma_f32_16x16x32_bf16 v[56:59], v[236:239], v[192:195], 0
  ds_read_b128 v[232:235], v244 offset:32768
  v_mfma_f32_16x16x32_bf16 v[60:63], v[236:239], v[196:199], 0
  s_waitcnt lgkmcnt(3)
  v_mfma_f32_16x16x32_bf16 v[56:59], v[240:243], v[200:203], v[56:59]
  ds_read_b128 v[236:239], v120 offset:32768
  v_mfma_f32_16x16x32_bf16 v[60:63], v[240:243], v[204:207], v[60:63]
  s_waitcnt lgkmcnt(3)
  v_mfma_f32_16x16x32_bf16 v[56:59], v[224:227], v[208:211], v[56:59]
  ds_read_b128 v[240:243], v121 offset:32768
  s_add_u32 m0, s31, 106496
  s_add_u32 s38, s30, 40960
  buffer_load_dwordx4 v128, s[20:23], s38 offen nt lds
  v_mfma_f32_16x16x32_bf16 v[60:63], v[224:227], v[212:215], v[60:63]
  s_waitcnt lgkmcnt(3)
  v_mfma_f32_16x16x32_bf16 v[56:59], v[228:231], v[216:219], v[56:59]
  ds_read_b128 v[224:227], v122 offset:32768
  v_mfma_f32_16x16x32_bf16 v[60:63], v[228:231], v[220:223], v[60:63]
  s_waitcnt lgkmcnt(3)
  v_mfma_f32_16x16x32_bf16 v[64:67], v[232:235], v[192:195], 0
  ds_read_b128 v[228:231], v244 offset:36864
  v_mfma_f32_16x16x32_bf16 v[68:71], v[232:235], v[196:199], 0
  s_waitcnt lgkmcnt(3)
  v_mfma_f32_16x16x32_bf16 v[64:67], v[236:239], v[200:203], v[64:67]
  ds_read_b128 v[232:235], v120 offset:36864
  v_mfma_f32_16x16x32_bf16 v[68:71], v[236:239], v[204:207], v[68:71]
  s_waitcnt lgkmcnt(3)
  v_mfma_f32_16x16x32_bf16 v[64:67], v[240:243], v[208:211], v[64:67]
  ds_read_b128 v[236:239], v121 offset:36864
  s_add_u32 m0, s28, 114688
  s_add_u32 s38, s29, 49152
  buffer_load_dwordx4 v128, s[20:23], s38 offen nt lds
  v_mfma_f32_16x16x32_bf16 v[68:71], v[240:243], v[212:215], v[68:71]
  s_waitcnt lgkmcnt(3)
  v_mfma_f32_16x16x32_bf16 v[64:67], v[224:227], v[216:219], v[64:67]
  ds_read_b128 v[240:243], v122 offset:36864
  v_mfma_f32_16x16x32_bf16 v[68:71], v[224:227], v[220:223], v[68:71]
  s_waitcnt lgkmcnt(3)
  v_mfma_f32_16x16x32_bf16 v[72:75], v[228:231], v[192:195], 0
  ds_read_b128 v[224:227], v244 offset:40960
  v_mfma_f32_16x16x32_bf16 v[76:79], v[228:231], v[196:199], 0
  s_waitcnt lgkmcnt(3)
  v_mfma_f32_16x16x32_bf16 v[72:75], v[232:235], v[200:203], v[72:75]
  ds_read_b128 v[228:231], v120 offset:40960
  v_mfma_f32_16x16x32_bf16 v[76:79], v[232:235], v[204:207], v[76:79]
  s_waitcnt lgkmcnt(3)
  v_mfma_f32_16x16x32_bf16 v[72:75], v[236:239], v[208:211], v[72:75]
  ds_read_b128 v[232:235], v121 offset:40960
  s_add_u32 m0, s31, 114688
  s_add_u32 s38, s30, 49152
  buffer_load_dwordx4 v128, s[20:23], s38 offen nt lds
  v_mfma_f32_16x16x32_bf16 v[76:79], v[236:239], v[212:215], v[76:79]
  s_waitcnt lgkmcnt(3)
  v_mfma_f32_16x16x32_bf16 v[72:75], v[240:243], v[216:219], v[72:75]
  ds_read_b128 v[236:239], v122 offset:40960
  v_mfma_f32_16x16x32_bf16 v[76:79], v[240:243], v[220:223], v[76:79]
  s_waitcnt lgkmcnt(3)
  v_mfma_f32_16x16x32_bf16 v[80:83], v[224:227], v[192:195], 0
  ds_read_b128 v[240:243], v244 offset:45056
  v_mfma_f32_16x16x32_bf16 v[84:87], v[224:227], v[196:199], 0
  s_waitcnt lgkmcnt(3)
  v_mfma_f32_16x16x32_bf16 v[80:83], v[228:231], v[200:203], v[80:83]
  ds_read_b128 v[224:227], v120 offset:45056
  v_mfma_f32_16x16x32_bf16 v[84:87], v[228:231], v[204:207], v[84:87]
  s_waitcnt lgkmcnt(3)
  v_mfma_f32_16x16x32_bf16 v[80:83], v[232:235], v[208:211], v[80:83]
  ds_read_b128 v[228:231], v121 offset:45056
  s_add_u32 m0, s28, 122880
  s_add_u32 s38, s29, 57344
  buffer_load_dwordx4 v128, s[20:23], s38 offen nt lds
  v_mfma_f32_16x16x32_bf16 v[84:87], v[232:235], v[212:215], v[84:87]
  s_waitcnt lgkmcnt(3)
  v_mfma_f32_16x16x32_bf16 v[80:83], v[236:239], v[216:219], v[80:83]
  ds_read_b128 v[232:235], v122 offset:45056
  v_mfma_f32_16x16x32_bf16 v[84:87], v[236:239], v[220:223], v[84:87]
  s_waitcnt lgkmcnt(3)
  v_mfma_f32_16x16x32_bf16 v[88:91], v[240:243], v[192:195], 0
  ds_read_b128 v[236:239], v244 offset:49152
  v_mfma_f32_16x16x32_bf16 v[92:95], v[240:243], v[196:199], 0
  s_waitcnt lgkmcnt(3)
  v_mfma_f32_16x16x32_bf16 v[88:91], v[224:227], v[200:203], v[88:91]
  ds_read_b128 v[240:243], v120 offset:49152
  v_mfma_f32_16x16x32_bf16 v[92:95], v[224:227], v[204:207], v[92:95]
  s_waitcnt lgkmcnt(3)
  v_mfma_f32_16x16x32_bf16 v[88:91], v[228:231], v[208:211], v[88:91]
  ds_read_b128 v[224:227], v121 offset:49152
  s_add_u32 m0, s31, 122880
  s_add_u32 s38, s30, 57344
  buffer_load_dwordx4 v128, s[20:23], s38 offen nt lds
  v_mfma_f32_16x16x32_bf16 v[92:95], v[228:231], v[212:215], v[92:95]
  s_waitcnt lgkmcnt(3)
  v_mfma_f32_16x16x32_bf16 v[88:91], v[232:235], v[216:219], v[88:91]
  ds_read_b128 v[228:231], v122 offset:49152
  v_mfma_f32_16x16x32_bf16 v[92:95], v[232:235], v[220:223], v[92:95]
  s_waitcnt lgkmcnt(3)
  v_mfma_f32_16x16x32_bf16 v[96:99], v[236:239], v[192:195], 0
  ds_read_b128 v[232:235], v244 offset:53248
  v_mfma_f32_16x16x32_bf16 v[100:103], v[236:239], v[196:199], 0
  s_waitcnt lgkmcnt(3)
  v_mfma_f32_16x16x32_bf16 v[96:99], v[240:243], v[200:203], v[96:99]
  ds_read_b128 v[236:239], v120 offset:53248
  v_mfma_f32_16x16x32_bf16 v[100:103], v[240:243], v[204:207], v[100:103]
  s_waitcnt lgkmcnt(3)
  v_mfma_f32_16x16x32_bf16 v[96:99], v[224:227], v[208:211], v[96:99]
  ds_read_b128 v[240:243], v121 offset:53248
  v_mfma_f32_16x16x32_bf16 v[100:103], v[224:227], v[212:215], v[100:103]
  s_waitcnt lgkmcnt(3)
  v_mfma_f32_16x16x32_bf16 v[96:99], v[228:231], v[216:219], v[96:99]
  ds_read_b128 v[224:227], v122 offset:53248
  v_mfma_f32_16x16x32_bf16 v[100:103], v[228:231], v[220:223], v[100:103]
  s_waitcnt lgkmcnt(3)
  v_mfma_f32_16x16x32_bf16 v[104:107], v[232:235], v[192:195], 0
  ds_read_b128 v[228:231], v244 offset:57344
  v_mfma_f32_16x16x32_bf16 v[108:111], v[232:235], v[196:199], 0
  s_waitcnt lgkmcnt(3)
  v_mfma_f32_16x16x32_bf16 v[104:107], v[236:239], v[200:203], v[104:107]
  ds_read_b128 v[232:235], v120 offset:57344
  v_mfma_f32_16x16x32_bf16 v[108:111], v[236:239], v[204:207], v[108:111]
  s_waitcnt lgkmcnt(3)
  v_mfma_f32_16x16x32_bf16 v[104:107], v[240:243], v[208:211], v[104:107]
  ds_read_b128 v[236:239], v121 offset:57344
  v_mfma_f32_16x16x32_bf16 v[108:111], v[240:243], v[212:215], v[108:111]
  s_waitcnt lgkmcnt(3)
  v_mfma_f32_16x16x32_bf16 v[104:107], v[224:227], v[216:219], v[104:107]
  ds_read_b128 v[240:243], v122 offset:57344
  v_mfma_f32_16x16x32_bf16 v[108:111], v[224:227], v[220:223], v[108:111]
  s_waitcnt lgkmcnt(3)
  v_mfma_f32_16x16x32_bf16 v[112:115], v[228:231], v[192:195], 0
  ds_read_b128 v[224:227], v244 offset:61440
  v_mfma_f32_16x16x32_bf16 v[116:119], v[228:231], v[196:199], 0
  s_waitcnt lgkmcnt(3)
  v_mfma_f32_16x16x32_bf16 v[112:115], v[232:235], v[200:203], v[112:115]
  ds_read_b128 v[228:231], v120 offset:61440
  v_mfma_f32_16x16x32_bf16 v[116:119], v[232:235], v[204:207], v[116:119]
  s_waitcnt lgkmcnt(3)
  v_mfma_f32_16x16x32_bf16 v[112:115], v[236:239], v[208:211], v[112:115]
  ds_read_b128 v[232:235], v121 offset:61440
  v_mfma_f32_16x16x32_bf16 v[116:119], v[236:239], v[212:215], v[116:119]
  s_waitcnt lgkmcnt(3)
  v_mfma_f32_16x16x32_bf16 v[112:115], v[240:243], v[216:219], v[112:115]
  ds_read_b128 v[236:239], v122 offset:61440
  v_mfma_f32_16x16x32_bf16 v[116:119], v[240:243], v[220:223], v[116:119]
  s_waitcnt lgkmcnt(3)
  v_mfma_f32_16x16x32_bf16 v[120:123], v[224:227], v[192:195], 0
  v_mfma_f32_16x16x32_bf16 v[124:127], v[224:227], v[196:199], 0
  s_waitcnt lgkmcnt(2)
  v_mfma_f32_16x16x32_bf16 v[120:123], v[228:231], v[200:203], v[120:123]
  v_mfma_f32_16x16x32_bf16 v[124:127], v[228:231], v[204:207], v[124:127]
  s_waitcnt lgkmcnt(1)
  v_mfma_f32_16x16x32_bf16 v[120:123], v[232:235], v[208:211], v[120:123]
  v_mfma_f32_16x16x32_bf16 v[124:127], v[232:235], v[212:215], v[124:127]
  s_waitcnt lgkmcnt(0)
  v_mfma_f32_16x16x32_bf16 v[120:123], v[236:239], v[216:219], v[120:123]
  v_mfma_f32_16x16x32_bf16 v[124:127], v[236:239], v[220:223], v[124:127]
  s_add_u32 s36, s32, 0x10000
  s_add_u32 s37, s33, 0x10000
  s_add_u32 s39, s32, s54
  s_add_u32 s40, s33, s54
  v_xor_b32 v236, 64, v246
  s_add_u32 m0, s43, 0x0
  s_nop 0
  buffer_load_dwordx4 v246, s[12:15], s36 offen offset:0 nt lds
  s_add_u32 m0, s43, 0xfffffc00
  s_nop 0
  buffer_load_dwordx4 v236, s[12:15], s36 offen offset:2048 nt lds
  s_add_u32 m0, s43, 0x800
  s_nop 0
  buffer_load_dwordx4 v246, s[12:15], s37 offen offset:0 nt lds
  s_add_u32 m0, s43, 0x400
  s_nop 0
  buffer_load_dwordx4 v236, s[12:15], s37 offen offset:2048 nt lds
  v_mbcnt_lo_u32_b32 v224, -1, 0
  v_mbcnt_hi_u32_b32 v224, -1, v224
  v_lshrrev_b32 v225, 4, v224
  v_bfe_u32 v226, v224, 2, 2
  v_and_b32 v227, 3, v224
  v_lshrrev_b32 v228, 1, v227
  v_lshl_add_u32 v228, v225, 1, v228
  v_lshlrev_b32 v229, 2, v226
  v_xor_b32 v228, v228, v229
  v_lshlrev_b32 v228, 4, v228
  v_lshl_add_u32 v228, v226, 8, v228
  v_and_b32 v229, 1, v227
  v_lshl_add_u32 v228, v229, 3, v228
  s_add_u32 s38, s28, 0x10000
  v_add_u32 v228, s38, v228
  v_xor_b32 v229, 128, v228
  v_and_b32 v230, 15, v224
  v_and_b32 v231, 7, v230
  v_lshrrev_b32 v232, 3, v230
  v_lshl_add_u32 v232, v225, 1, v232
  v_xor_b32 v232, v232, v231
  v_lshlrev_b32 v232, 4, v232
  v_and_b32 v233, 3, v231
  v_lshl_add_u32 v232, v233, 8, v232
  v_lshrrev_b32 v233, 2, v231
  v_lshl_add_u32 v232, v233, 12, v232
  v_add_u32 v232, s38, v232
  s_waitcnt vmcnt(18)
  ds_read_b64_tr_b16 v[128:129], v228 offset:0
  ds_read_b64_tr_b16 v[130:131], v228 offset:4096
  ds_read_b64_tr_b16 v[132:133], v229 offset:0
  ds_read_b64_tr_b16 v[134:135], v229 offset:4096
  s_waitcnt vmcnt(16)
  ds_read_b64_tr_b16 v[136:137], v228 offset:8192
  ds_read_b64_tr_b16 v[138:139], v228 offset:12288
  ds_read_b64_tr_b16 v[140:141], v229 offset:8192
  ds_read_b64_tr_b16 v[142:143], v229 offset:12288
  s_waitcnt lgkmcnt(4)
  ds_write_b128 v232, v[128:131] offset:0
  ds_write_b128 v232, v[132:135] offset:128
  s_waitcnt vmcnt(14)
  ds_read_b64_tr_b16 v[144:145], v228 offset:16384
  ds_read_b64_tr_b16 v[146:147], v228 offset:20480
  ds_read_b64_tr_b16 v[148:149], v229 offset:16384
  ds_read_b64_tr_b16 v[150:151], v229 offset:20480
  s_waitcnt lgkmcnt(6)
  ds_write_b128 v232, v[136:139] offset:8192
  ds_write_b128 v232, v[140:143] offset:8320
  s_waitcnt vmcnt(12)
  ds_read_b64_tr_b16 v[152:153], v228 offset:24576
  ds_read_b64_tr_b16 v[154:155], v228 offset:28672
  ds_read_b64_tr_b16 v[156:157], v229 offset:24576
  ds_read_b64_tr_b16 v[158:159], v229 offset:28672
  s_waitcnt lgkmcnt(6)
  ds_write_b128 v232, v[144:147] offset:16384
  ds_write_b128 v232, v[148:151] offset:16512
  s_waitcnt vmcnt(10)
  ds_read_b64_tr_b16 v[160:161], v228 offset:32768
  ds_read_b64_tr_b16 v[162:163], v228 offset:36864
  ds_read_b64_tr_b16 v[164:165], v229 offset:32768
  ds_read_b64_tr_b16 v[166:167], v229 offset:36864
  s_waitcnt lgkmcnt(6)
  ds_write_b128 v232, v[152:155] offset:24576
  ds_write_b128 v232, v[156:159] offset:24704
  s_waitcnt vmcnt(8)
  ds_read_b64_tr_b16 v[168:169], v228 offset:40960
  ds_read_b64_tr_b16 v[170:171], v228 offset:45056
  ds_read_b64_tr_b16 v[172:173], v229 offset:40960
  ds_read_b64_tr_b16 v[174:175], v229 offset:45056
  s_waitcnt lgkmcnt(6)
  ds_write_b128 v232, v[160:163] offset:32768
  ds_write_b128 v232, v[164:167] offset:32896
  s_waitcnt vmcnt(6)
  ds_read_b64_tr_b16 v[176:177], v228 offset:49152
  ds_read_b64_tr_b16 v[178:179], v228 offset:53248
  ds_read_b64_tr_b16 v[180:181], v229 offset:49152
  ds_read_b64_tr_b16 v[182:183], v229 offset:53248
  s_waitcnt lgkmcnt(6)
  ds_write_b128 v232, v[168:171] offset:40960
  ds_write_b128 v232, v[172:175] offset:41088
  s_waitcnt vmcnt(4)
  ds_read_b64_tr_b16 v[184:185], v228 offset:57344
  ds_read_b64_tr_b16 v[186:187], v228 offset:61440
  ds_read_b64_tr_b16 v[188:189], v229 offset:57344
  ds_read_b64_tr_b16 v[190:191], v229 offset:61440
  s_waitcnt lgkmcnt(6)
  ds_write_b128 v232, v[176:179] offset:49152
  ds_write_b128 v232, v[180:183] offset:49280
  s_waitcnt lgkmcnt(2)
  ds_write_b128 v232, v[184:187] offset:57344
  ds_write_b128 v232, v[188:191] offset:57472
  s_waitcnt lgkmcnt(0)
  s_mov_b64 s[6:7], 0
  s_barrier
  s_branch L_e
L_p_c_3:
  s_sub_u32 s32, s32, 0x10000
  s_sub_u32 s33, s33, 0x10000
  s_mov_b32 s41, -1
  v_xor_b32 v120, 64, v244
  v_xor_b32 v121, 128, v244
  v_xor_b32 v122, 192, v244
  ds_read_b128 v[224:227], v244 offset:0
  ds_read_b128 v[228:231], v120 offset:0
  ds_read_b128 v[232:235], v121 offset:0
  ds_read_b128 v[236:239], v122 offset:0
  s_setprio 1
L_cont:
  s_waitcnt lgkmcnt(3)
  v_mfma_f32_16x16x32_bf16 v[0:3], v[224:227], v[192:195], 0
  ds_read_b128 v[240:243], v244 offset:4096
  v_mfma_f32_16x16x32_bf16 v[4:7], v[224:227], v[196:199], 0
  s_waitcnt lgkmcnt(3)
  v_mfma_f32_16x16x32_bf16 v[0:3], v[228:231], v[200:203], v[0:3]
  ds_read_b128 v[224:227], v120 offset:4096
  s_mov_b32 s34, s32
  v_mfma_f32_16x16x32_bf16 v[4:7], v[228:231], v[204:207], v[4:7]
  s_waitcnt lgkmcnt(3)
  v_mfma_f32_16x16x32_bf16 v[0:3], v[232:235], v[208:211], v[0:3]
  ds_read_b128 v[228:231], v121 offset:4096
  s_mov_b32 s35, s33
  v_mfma_f32_16x16x32_bf16 v[4:7], v[232:235], v[212:215], v[4:7]
  s_waitcnt lgkmcnt(3)
  v_mfma_f32_16x16x32_bf16 v[0:3], v[236:239], v[216:219], v[0:3]
  ds_read_b128 v[232:235], v122 offset:4096
  s_add_u32 s32, s32, 0x10000
  v_mfma_f32_16x16x32_bf16 v[4:7], v[236:239], v[220:223], v[4:7]
  s_waitcnt lgkmcnt(3)
  v_mfma_f32_16x16x32_bf16 v[8:11], v[240:243], v[192:195], 0
  ds_read_b128 v[236:239], v244 offset:8192
  s_add_u32 s33, s33, 0x10000
  v_mfma_f32_16x16x32_bf16 v[12:15], v[240:243], v[196:199], 0
  s_waitcnt lgkmcnt(3)
  v_mfma_f32_16x16x32_bf16 v[8:11], v[224:227], v[200:203], v[8:11]
  ds_read_b128 v[240:243], v120 offset:8192
  s_add_u32 s41, s41, 1
  v_mfma_f32_16x16x32_bf16 v[12:15], v[224:227], v[204:207], v[12:15]
  s_waitcnt lgkmcnt(3)
  v_mfma_f32_16x16x32_bf16 v[8:11], v[228:231], v[208:211], v[8:11]
  ds_read_b128 v[224:227], v121 offset:8192
  s_add_u32 s36, s32, 0x10000
  v_mfma_f32_16x16x32_bf16 v[12:15], v[228:231], v[212:215], v[12:15]
  s_waitcnt lgkmcnt(3)
  v_mfma_f32_16x16x32_bf16 v[8:11], v[232:235], v[216:219], v[8:11]
  ds_read_b128 v[228:231], v122 offset:8192
  s_add_u32 s37, s33, 0x10000
  v_mfma_f32_16x16x32_bf16 v[12:15], v[232:235], v[220:223], v[12:15]
  s_waitcnt lgkmcnt(3)
  v_mfma_f32_16x16x32_bf16 v[16:19], v[236:239], v[192:195], 0
  ds_read_b128 v[232:235], v244 offset:12288
  s_add_u32 s39, s32, s54
  v_mfma_f32_16x16x32_bf16 v[20:23], v[236:239], v[196:199], 0
  s_waitcnt lgkmcnt(3)
  v_mfma_f32_16x16x32_bf16 v[16:19], v[240:243], v[200:203], v[16:19]
  ds_read_b128 v[236:239], v120 offset:12288
  s_add_u32 s40, s33, s54
  v_mfma_f32_16x16x32_bf16 v[20:23], v[240:243], v[204:207], v[20:23]
  s_waitcnt lgkmcnt(3)
  v_mfma_f32_16x16x32_bf16 v[16:19], v[224:227], v[208:211], v[16:19]
  ds_read_b128 v[240:243], v121 offset:12288
  s_cmp_eq_u32 s41, 3
  s_cselect_b64 s[6:7], -1, 0
  v_mfma_f32_16x16x32_bf16 v[20:23], v[224:227], v[212:215], v[20:23]
  s_waitcnt lgkmcnt(3)
  v_mfma_f32_16x16x32_bf16 v[16:19], v[228:231], v[216:219], v[16:19]
  ds_read_b128 v[224:227], v122 offset:12288
  s_cmp_eq_u32 s41, s45
  s_cselect_b64 s[6:7], -1, s[6:7]
  v_mfma_f32_16x16x32_bf16 v[20:23], v[228:231], v[220:223], v[20:23]
  s_waitcnt lgkmcnt(3)
  v_mfma_f32_16x16x32_bf16 v[24:27], v[232:235], v[192:195], 0
  ds_read_b128 v[228:231], v244 offset:16384
  v_mfma_f32_16x16x32_bf16 v[28:31], v[232:235], v[196:199], 0
  s_waitcnt lgkmcnt(3)
  v_mfma_f32_16x16x32_bf16 v[24:27], v[236:239], v[200:203], v[24:27]
  ds_read_b128 v[232:235], v120 offset:16384
  v_mfma_f32_16x16x32_bf16 v[28:31], v[236:239], v[204:207], v[28:31]
  s_waitcnt lgkmcnt(3)
  v_mfma_f32_16x16x32_bf16 v[24:27], v[240:243], v[208:211], v[24:27]
  ds_read_b128 v[236:239], v121 offset:16384
  v_mfma_f32_16x16x32_bf16 v[28:31], v[240:243], v[212:215], v[28:31]
  s_waitcnt lgkmcnt(3)
  v_mfma_f32_16x16x32_bf16 v[24:27], v[224:227], v[216:219], v[24:27]
  ds_read_b128 v[240:243], v122 offset:16384
  v_mfma_f32_16x16x32_bf16 v[28:31], v[224:227], v[220:223], v[28:31]
  s_waitcnt lgkmcnt(3)
  v_mfma_f32_16x16x32_bf16 v[32:35], v[228:231], v[192:195], 0
  ds_read_b128 v[224:227], v244 offset:20480
  v_mfma_f32_16x16x32_bf16 v[36:39], v[228:231], v[196:199], 0
  s_waitcnt lgkmcnt(3)
  v_mfma_f32_16x16x32_bf16 v[32:35], v[232:235], v[200:203], v[32:35]
  ds_read_b128 v[228:231], v120 offset:20480
  v_mfma_f32_16x16x32_bf16 v[36:39], v[232:235], v[204:207], v[36:39]
  s_waitcnt lgkmcnt(3)
  v_mfma_f32_16x16x32_bf16 v[32:35], v[236:239], v[208:211], v[32:35]
  ds_read_b128 v[232:235], v121 offset:20480
  v_mfma_f32_16x16x32_bf16 v[36:39], v[236:239], v[212:215], v[36:39]
  s_waitcnt lgkmcnt(3)
  v_mfma_f32_16x16x32_bf16 v[32:35], v[240:243], v[216:219], v[32:35]
  ds_read_b128 v[236:239], v122 offset:20480
  v_mfma_f32_16x16x32_bf16 v[36:39], v[240:243], v[220:223], v[36:39]
  s_waitcnt lgkmcnt(3)
  v_mfma_f32_16x16x32_bf16 v[40:43], v[224:227], v[192:195], 0
  ds_read_b128 v[240:243], v244 offset:24576
  v_mfma_f32_16x16x32_bf16 v[44:47], v[224:227], v[196:199], 0
  s_waitcnt lgkmcnt(3)
  v_mfma_f32_16x16x32_bf16 v[40:43], v[228:231], v[200:203], v[40:43]
  ds_read_b128 v[224:227], v120 offset:24576
  v_mfma_f32_16x16x32_bf16 v[44:47], v[228:231], v[204:207], v[44:47]
  s_waitcnt lgkmcnt(3)
  v_mfma_f32_16x16x32_bf16 v[40:43], v[232:235], v[208:211], v[40:43]
  ds_read_b128 v[228:231], v121 offset:24576
  v_mfma_f32_16x16x32_bf16 v[44:47], v[232:235], v[212:215], v[44:47]
  s_waitcnt lgkmcnt(3)
  v_mfma_f32_16x16x32_bf16 v[40:43], v[236:239], v[216:219], v[40:43]
  ds_read_b128 v[232:235], v122 offset:24576
  v_mfma_f32_16x16x32_bf16 v[44:47], v[236:239], v[220:223], v[44:47]
  s_waitcnt lgkmcnt(3)
  v_mfma_f32_16x16x32_bf16 v[48:51], v[240:243], v[192:195], 0
  ds_read_b128 v[236:239], v244 offset:28672
  v_mfma_f32_16x16x32_bf16 v[52:55], v[240:243], v[196:199], 0
  s_waitcnt lgkmcnt(3)
  v_mfma_f32_16x16x32_bf16 v[48:51], v[224:227], v[200:203], v[48:51]
  ds_read_b128 v[240:243], v120 offset:28672
  v_mfma_f32_16x16x32_bf16 v[52:55], v[224:227], v[204:207], v[52:55]
  s_waitcnt lgkmcnt(3)
  v_mfma_f32_16x16x32_bf16 v[48:51], v[228:231], v[208:211], v[48:51]
  ds_read_b128 v[224:227], v121 offset:28672
  v_mfma_f32_16x16x32_bf16 v[52:55], v[228:231], v[212:215], v[52:55]
  s_waitcnt lgkmcnt(3)
  v_mfma_f32_16x16x32_bf16 v[48:51], v[232:235], v[216:219], v[48:51]
  ds_read_b128 v[228:231], v122 offset:28672
  v_mfma_f32_16x16x32_bf16 v[52:55], v[232:235], v[220:223], v[52:55]
  s_waitcnt lgkmcnt(3)
  v_mfma_f32_16x16x32_bf16 v[56:59], v[236:239], v[192:195], 0
  ds_read_b128 v[232:235], v244 offset:32768
  v_mfma_f32_16x16x32_bf16 v[60:63], v[236:239], v[196:199], 0
  s_waitcnt lgkmcnt(3)
  v_mfma_f32_16x16x32_bf16 v[56:59], v[240:243], v[200:203], v[56:59]
  ds_read_b128 v[236:239], v120 offset:32768
  v_mfma_f32_16x16x32_bf16 v[60:63], v[240:243], v[204:207], v[60:63]
  s_waitcnt lgkmcnt(3)
  v_mfma_f32_16x16x32_bf16 v[56:59], v[224:227], v[208:211], v[56:59]
  ds_read_b128 v[240:243], v121 offset:32768
  v_mfma_f32_16x16x32_bf16 v[60:63], v[224:227], v[212:215], v[60:63]
  s_waitcnt lgkmcnt(3)
  v_mfma_f32_16x16x32_bf16 v[56:59], v[228:231], v[216:219], v[56:59]
  ds_read_b128 v[224:227], v122 offset:32768
  v_mfma_f32_16x16x32_bf16 v[60:63], v[228:231], v[220:223], v[60:63]
  s_waitcnt lgkmcnt(3)
  v_mfma_f32_16x16x32_bf16 v[64:67], v[232:235], v[192:195], 0
  ds_read_b128 v[228:231], v244 offset:36864
  v_mfma_f32_16x16x32_bf16 v[68:71], v[232:235], v[196:199], 0
  s_waitcnt lgkmcnt(3)
  v_mfma_f32_16x16x32_bf16 v[64:67], v[236:239], v[200:203], v[64:67]
  ds_read_b128 v[232:235], v120 offset:36864
  v_mfma_f32_16x16x32_bf16 v[68:71], v[236:239], v[204:207], v[68:71]
  s_waitcnt lgkmcnt(3)
  v_mfma_f32_16x16x32_bf16 v[64:67], v[240:243], v[208:211], v[64:67]
  ds_read_b128 v[236:239], v121 offset:36864
  v_mfma_f32_16x16x32_bf16 v[68:71], v[240:243], v[212:215], v[68:71]
  s_waitcnt lgkmcnt(3)
  v_mfma_f32_16x16x32_bf16 v[64:67], v[224:227], v[216:219], v[64:67]
  ds_read_b128 v[240:243], v122 offset:36864
  v_mfma_f32_16x16x32_bf16 v[68:71], v[224:227], v[220:223], v[68:71]
  s_waitcnt lgkmcnt(3)
  v_mfma_f32_16x16x32_bf16 v[72:75], v[228:231], v[192:195], 0
  ds_read_b128 v[224:227], v244 offset:40960
  v_mfma_f32_16x16x32_bf16 v[76:79], v[228:231], v[196:199], 0
  s_waitcnt lgkmcnt(3)
  v_mfma_f32_16x16x32_bf16 v[72:75], v[232:235], v[200:203], v[72:75]
  ds_read_b128 v[228:231], v120 offset:40960
  v_mfma_f32_16x16x32_bf16 v[76:79], v[232:235], v[204:207], v[76:79]
  s_waitcnt lgkmcnt(3)
  v_mfma_f32_16x16x32_bf16 v[72:75], v[236:239], v[208:211], v[72:75]
  ds_read_b128 v[232:235], v121 offset:40960
  v_mfma_f32_16x16x32_bf16 v[76:79], v[236:239], v[212:215], v[76:79]
  s_waitcnt lgkmcnt(3)
  v_mfma_f32_16x16x32_bf16 v[72:75], v[240:243], v[216:219], v[72:75]
  ds_read_b128 v[236:239], v122 offset:40960
  v_mfma_f32_16x16x32_bf16 v[76:79], v[240:243], v[220:223], v[76:79]
  s_waitcnt lgkmcnt(3)
  v_mfma_f32_16x16x32_bf16 v[80:83], v[224:227], v[192:195], 0
  ds_read_b128 v[240:243], v244 offset:45056
  v_mfma_f32_16x16x32_bf16 v[84:87], v[224:227], v[196:199], 0
  s_waitcnt lgkmcnt(3)
  v_mfma_f32_16x16x32_bf16 v[80:83], v[228:231], v[200:203], v[80:83]
  ds_read_b128 v[224:227], v120 offset:45056
  v_mfma_f32_16x16x32_bf16 v[84:87], v[228:231], v[204:207], v[84:87]
  s_waitcnt lgkmcnt(3)
  v_mfma_f32_16x16x32_bf16 v[80:83], v[232:235], v[208:211], v[80:83]
  ds_read_b128 v[228:231], v121 offset:45056
  v_mfma_f32_16x16x32_bf16 v[84:87], v[232:235], v[212:215], v[84:87]
  s_waitcnt lgkmcnt(3)
  v_mfma_f32_16x16x32_bf16 v[80:83], v[236:239], v[216:219], v[80:83]
  ds_read_b128 v[232:235], v122 offset:45056
  v_mfma_f32_16x16x32_bf16 v[84:87], v[236:239], v[220:223], v[84:87]
  s_waitcnt lgkmcnt(3)
  v_mfma_f32_16x16x32_bf16 v[88:91], v[240:243], v[192:195], 0
  ds_read_b128 v[236:239], v244 offset:49152
  v_mfma_f32_16x16x32_bf16 v[92:95], v[240:243], v[196:199], 0
  s_waitcnt lgkmcnt(3)
  v_mfma_f32_16x16x32_bf16 v[88:91], v[224:227], v[200:203], v[88:91]
  ds_read_b128 v[240:243], v120 offset:49152
  v_mfma_f32_16x16x32_bf16 v[92:95], v[224:227], v[204:207], v[92:95]
  s_waitcnt lgkmcnt(3)
  v_mfma_f32_16x16x32_bf16 v[88:91], v[228:231], v[208:211], v[88:91]
  ds_read_b128 v[224:227], v121 offset:49152
  v_mfma_f32_16x16x32_bf16 v[92:95], v[228:231], v[212:215], v[92:95]
  s_waitcnt lgkmcnt(3)
  v_mfma_f32_16x16x32_bf16 v[88:91], v[232:235], v[216:219], v[88:91]
  ds_read_b128 v[228:231], v122 offset:49152
  v_mfma_f32_16x16x32_bf16 v[92:95], v[232:235], v[220:223], v[92:95]
  s_waitcnt lgkmcnt(3)
  v_mfma_f32_16x16x32_bf16 v[96:99], v[236:239], v[192:195], 0
  ds_read_b128 v[232:235], v244 offset:53248
  v_mfma_f32_16x16x32_bf16 v[100:103], v[236:239], v[196:199], 0
  s_waitcnt lgkmcnt(3)
  v_mfma_f32_16x16x32_bf16 v[96:99], v[240:243], v[200:203], v[96:99]
  ds_read_b128 v[236:239], v120 offset:53248
  v_mfma_f32_16x16x32_bf16 v[100:103], v[240:243], v[204:207], v[100:103]
  s_waitcnt lgkmcnt(3)
  v_mfma_f32_16x16x32_bf16 v[96:99], v[224:227], v[208:211], v[96:99]
  ds_read_b128 v[240:243], v121 offset:53248
  v_mfma_f32_16x16x32_bf16 v[100:103], v[224:227], v[212:215], v[100:103]
  s_waitcnt lgkmcnt(3)
  v_mfma_f32_16x16x32_bf16 v[96:99], v[228:231], v[216:219], v[96:99]
  ds_read_b128 v[224:227], v122 offset:53248
  v_mfma_f32_16x16x32_bf16 v[100:103], v[228:231], v[220:223], v[100:103]
  s_waitcnt lgkmcnt(3)
  v_mfma_f32_16x16x32_bf16 v[104:107], v[232:235], v[192:195], 0
  ds_read_b128 v[228:231], v244 offset:57344
  v_mfma_f32_16x16x32_bf16 v[108:111], v[232:235], v[196:199], 0
  s_waitcnt lgkmcnt(3)
  v_mfma_f32_16x16x32_bf16 v[104:107], v[236:239], v[200:203], v[104:107]
  ds_read_b128 v[232:235], v120 offset:57344
  v_mfma_f32_16x16x32_bf16 v[108:111], v[236:239], v[204:207], v[108:111]
  s_waitcnt lgkmcnt(3)
  v_mfma_f32_16x16x32_bf16 v[104:107], v[240:243], v[208:211], v[104:107]
  ds_read_b128 v[236:239], v121 offset:57344
  v_mfma_f32_16x16x32_bf16 v[108:111], v[240:243], v[212:215], v[108:111]
  s_waitcnt lgkmcnt(3)
  v_mfma_f32_16x16x32_bf16 v[104:107], v[224:227], v[216:219], v[104:107]
  ds_read_b128 v[240:243], v122 offset:57344
  v_mfma_f32_16x16x32_bf16 v[108:111], v[224:227], v[220:223], v[108:111]
  s_waitcnt lgkmcnt(3)
  v_mfma_f32_16x16x32_bf16 v[112:115], v[228:231], v[192:195], 0
  ds_read_b128 v[224:227], v244 offset:61440
  v_mfma_f32_16x16x32_bf16 v[116:119], v[228:231], v[196:199], 0
  s_waitcnt lgkmcnt(3)
  v_mfma_f32_16x16x32_bf16 v[112:115], v[232:235], v[200:203], v[112:115]
  ds_read_b128 v[228:231], v120 offset:61440
  v_mfma_f32_16x16x32_bf16 v[116:119], v[232:235], v[204:207], v[116:119]
  s_waitcnt lgkmcnt(3)
  v_mfma_f32_16x16x32_bf16 v[112:115], v[236:239], v[208:211], v[112:115]
  ds_read_b128 v[232:235], v121 offset:61440
  v_mfma_f32_16x16x32_bf16 v[116:119], v[236:239], v[212:215], v[116:119]
  s_waitcnt lgkmcnt(3)
  v_mfma_f32_16x16x32_bf16 v[112:115], v[240:243], v[216:219], v[112:115]
  ds_read_b128 v[236:239], v122 offset:61440
  v_mfma_f32_16x16x32_bf16 v[116:119], v[240:243], v[220:223], v[116:119]
  s_waitcnt lgkmcnt(3)
  v_mfma_f32_16x16x32_bf16 v[120:123], v[224:227], v[192:195], 0
  v_mfma_f32_16x16x32_bf16 v[124:127], v[224:227], v[196:199], 0
  s_waitcnt lgkmcnt(2)
  v_mfma_f32_16x16x32_bf16 v[120:123], v[228:231], v[200:203], v[120:123]
  v_mfma_f32_16x16x32_bf16 v[124:127], v[228:231], v[204:207], v[124:127]
  s_waitcnt lgkmcnt(1)
  v_mfma_f32_16x16x32_bf16 v[120:123], v[232:235], v[208:211], v[120:123]
  v_mfma_f32_16x16x32_bf16 v[124:127], v[232:235], v[212:215], v[124:127]
  s_waitcnt lgkmcnt(0)
  v_mfma_f32_16x16x32_bf16 v[120:123], v[236:239], v[216:219], v[120:123]
  s_cmp_eq_u32 s41, 0
  v_mfma_f32_16x16x32_bf16 v[124:127], v[236:239], v[220:223], v[124:127]
  s_cbranch_scc1 L_e
  s_barrier
L_e:
  s_setprio 0
  v_xor_b32 v240, 64, v245
  s_waitcnt vmcnt(0)
  ds_read_b128 v[192:195], v245 offset:0
  ds_read_b128 v[196:199], v245 offset:2048
  ds_read_b128 v[200:203], v240 offset:0
  ds_read_b128 v[204:207], v240 offset:2048
  v_xor_b32 v241, 64, v246
  v_exp_f32 v0, v0
  v_exp_f32 v4, v4
  v_exp_f32 v1, v1
  v_exp_f32 v5, v5
  v_rcp_f32 v252, v252
  v_exp_f32 v2, v2
  v_exp_f32 v6, v6
  v_rcp_f32 v253, v253
  v_exp_f32 v3, v3
  v_exp_f32 v7, v7
  v_mov_b32_dpp v252, v252 row_ror:12 row_mask:0x2 bank_mask:0xf
  v_exp_f32 v8, v8
  v_exp_f32 v12, v12
  v_mov_b32_dpp v253, v253 row_ror:12 row_mask:0x2 bank_mask:0xf
  v_exp_f32 v9, v9
  s_add_u32 m0, s43, 0xffffff80
  v_exp_f32 v13, v13
  v_mov_b32_dpp v252, v252 row_ror:8 row_mask:0x4 bank_mask:0xf
  s_waitcnt lgkmcnt(0)
  s_cmp_lt_u32 s41, 3
  s_cselect_b32 s14, 0x4000000, 0
  buffer_load_dwordx4 v246, s[12:15], s36 offen offset:128 nt lds
  v_exp_f32 v10, v10
  v_exp_f32 v14, v14
  v_mov_b32_dpp v253, v253 row_ror:8 row_mask:0x4 bank_mask:0xf
  v_exp_f32 v11, v11
  v_exp_f32 v15, v15
  v_mov_b32_dpp v252, v252 row_ror:4 row_mask:0x8 bank_mask:0xf
  s_add_u32 m0, s43, 0xfffffb80
  v_cvt_pk_bf16_f32 v0, v0, v1
  buffer_load_dwordx4 v241, s[12:15], s36 offen offset:2176 nt lds
  v_cvt_pk_bf16_f32 v1, v2, v3
  v_mov_b32_dpp v253, v253 row_ror:4 row_mask:0x8 bank_mask:0xf
  v_cvt_pk_bf16_f32 v2, v8, v9
  v_cvt_pk_bf16_f32 v3, v10, v11
  v_cvt_pk_bf16_f32 v4, v4, v5
  s_add_u32 m0, s43, 0x780
  v_cvt_pk_bf16_f32 v5, v6, v7
  buffer_load_dwordx4 v246, s[12:15], s37 offen offset:128 nt lds
  v_cvt_pk_bf16_f32 v6, v12, v13
  v_cvt_pk_bf16_f32 v7, v14, v15
  v_exp_f32 v16, v16
  v_exp_f32 v20, v20
  s_add_u32 m0, s43, 0x380
  v_exp_f32 v17, v17
  buffer_load_dwordx4 v241, s[12:15], s37 offen offset:2176 nt lds
  v_exp_f32 v21, v21
  v_exp_f32 v18, v18
  v_exp_f32 v22, v22
  v_mul_f32_dpp v128, v252, v128 row_newbcast:0 row_mask:0xf bank_mask:0xf
  v_mul_f32_dpp v136, v252, v136 row_newbcast:0 row_mask:0xf bank_mask:0xf
  v_mul_f32_dpp v144, v252, v144 row_newbcast:0 row_mask:0xf bank_mask:0xf
  v_mul_f32_dpp v152, v252, v152 row_newbcast:0 row_mask:0xf bank_mask:0xf
  v_mul_f32_dpp v160, v252, v160 row_newbcast:0 row_mask:0xf bank_mask:0xf
  v_mul_f32_dpp v168, v252, v168 row_newbcast:0 row_mask:0xf bank_mask:0xf
  v_mul_f32_dpp v176, v252, v176 row_newbcast:0 row_mask:0xf bank_mask:0xf
  v_mul_f32_dpp v184, v252, v184 row_newbcast:0 row_mask:0xf bank_mask:0xf
  v_cvt_pk_bf16_f32 v224, v128, v136
  v_cvt_pk_bf16_f32 v225, v144, v152
  v_cvt_pk_bf16_f32 v226, v160, v168
  v_cvt_pk_bf16_f32 v227, v176, v184
  buffer_store_dwordx4 v[224:227], v247, s[24:27], s34 offen offset:0 sc0 sc1
  v_exp_f32 v19, v19
  v_exp_f32 v23, v23
  v_exp_f32 v24, v24
  v_exp_f32 v28, v28
  v_exp_f32 v25, v25
  v_exp_f32 v29, v29
  v_exp_f32 v26, v26
  v_exp_f32 v30, v30
  v_exp_f32 v27, v27
  v_exp_f32 v31, v31
  v_cvt_pk_bf16_f32 v8, v16, v17
  v_cvt_pk_bf16_f32 v9, v18, v19
  v_cvt_pk_bf16_f32 v10, v24, v25
  v_cvt_pk_bf16_f32 v11, v26, v27
  v_cvt_pk_bf16_f32 v12, v20, v21
  v_cvt_pk_bf16_f32 v13, v22, v23
  v_cvt_pk_bf16_f32 v14, v28, v29
  v_mul_f32_dpp v129, v252, v129 row_newbcast:1 row_mask:0xf bank_mask:0xf
  v_mul_f32_dpp v137, v252, v137 row_newbcast:1 row_mask:0xf bank_mask:0xf
  v_mul_f32_dpp v145, v252, v145 row_newbcast:1 row_mask:0xf bank_mask:0xf
  v_mul_f32_dpp v153, v252, v153 row_newbcast:1 row_mask:0xf bank_mask:0xf
  v_mul_f32_dpp v161, v252, v161 row_newbcast:1 row_mask:0xf bank_mask:0xf
  v_mul_f32_dpp v169, v252, v169 row_newbcast:1 row_mask:0xf bank_mask:0xf
  v_mul_f32_dpp v177, v252, v177 row_newbcast:1 row_mask:0xf bank_mask:0xf
  v_mul_f32_dpp v185, v252, v185 row_newbcast:1 row_mask:0xf bank_mask:0xf
  v_cvt_pk_bf16_f32 v228, v129, v137
  v_cvt_pk_bf16_f32 v229, v145, v153
  v_cvt_pk_bf16_f32 v230, v161, v169
  v_cvt_pk_bf16_f32 v231, v177, v185
  buffer_store_dwordx4 v[228:231], v247, s[24:27], s34 offen offset:256 sc0 sc1
  v_cvt_pk_bf16_f32 v15, v30, v31
  v_exp_f32 v32, v32
  v_exp_f32 v36, v36
  v_exp_f32 v33, v33
  v_exp_f32 v37, v37
  v_exp_f32 v34, v34
  v_exp_f32 v38, v38
  v_exp_f32 v35, v35
  v_exp_f32 v39, v39
  v_exp_f32 v40, v40
  v_exp_f32 v44, v44
  v_exp_f32 v41, v41
  v_exp_f32 v45, v45
  v_exp_f32 v42, v42
  v_exp_f32 v46, v46
  v_exp_f32 v43, v43
  v_exp_f32 v47, v47
  v_mul_f32_dpp v130, v252, v130 row_newbcast:2 row_mask:0xf bank_mask:0xf
  v_mul_f32_dpp v138, v252, v138 row_newbcast:2 row_mask:0xf bank_mask:0xf
  v_mul_f32_dpp v146, v252, v146 row_newbcast:2 row_mask:0xf bank_mask:0xf
  v_mul_f32_dpp v154, v252, v154 row_newbcast:2 row_mask:0xf bank_mask:0xf
  v_mul_f32_dpp v162, v252, v162 row_newbcast:2 row_mask:0xf bank_mask:0xf
  v_mul_f32_dpp v170, v252, v170 row_newbcast:2 row_mask:0xf bank_mask:0xf
  v_mul_f32_dpp v178, v252, v178 row_newbcast:2 row_mask:0xf bank_mask:0xf
  v_mul_f32_dpp v186, v252, v186 row_newbcast:2 row_mask:0xf bank_mask:0xf
  v_cvt_pk_bf16_f32 v232, v130, v138
  v_cvt_pk_bf16_f32 v233, v146, v154
  v_cvt_pk_bf16_f32 v234, v162, v170
  v_cvt_pk_bf16_f32 v235, v178, v186
  buffer_store_dwordx4 v[232:235], v247, s[24:27], s34 offen offset:512 sc0 sc1
  v_cvt_pk_bf16_f32 v16, v32, v33
  v_cvt_pk_bf16_f32 v17, v34, v35
  v_cvt_pk_bf16_f32 v18, v40, v41
  v_cvt_pk_bf16_f32 v19, v42, v43
  v_cvt_pk_bf16_f32 v20, v36, v37
  v_cvt_pk_bf16_f32 v21, v38, v39
  v_cvt_pk_bf16_f32 v22, v44, v45
  v_cvt_pk_bf16_f32 v23, v46, v47
  v_exp_f32 v48, v48
  v_exp_f32 v52, v52
  v_exp_f32 v49, v49
  v_exp_f32 v53, v53
  v_exp_f32 v50, v50
  v_exp_f32 v54, v54
  v_exp_f32 v51, v51
  v_exp_f32 v55, v55
  v_exp_f32 v56, v56
  v_mul_f32_dpp v131, v252, v131 row_newbcast:3 row_mask:0xf bank_mask:0xf
  v_mul_f32_dpp v139, v252, v139 row_newbcast:3 row_mask:0xf bank_mask:0xf
  v_mul_f32_dpp v147, v252, v147 row_newbcast:3 row_mask:0xf bank_mask:0xf
  v_mul_f32_dpp v155, v252, v155 row_newbcast:3 row_mask:0xf bank_mask:0xf
  v_mul_f32_dpp v163, v252, v163 row_newbcast:3 row_mask:0xf bank_mask:0xf
  v_mul_f32_dpp v171, v252, v171 row_newbcast:3 row_mask:0xf bank_mask:0xf
  v_mul_f32_dpp v179, v252, v179 row_newbcast:3 row_mask:0xf bank_mask:0xf
  v_mul_f32_dpp v187, v252, v187 row_newbcast:3 row_mask:0xf bank_mask:0xf
  v_cvt_pk_bf16_f32 v236, v131, v139
  v_cvt_pk_bf16_f32 v237, v147, v155
  v_cvt_pk_bf16_f32 v238, v163, v171
  v_cvt_pk_bf16_f32 v239, v179, v187
  buffer_store_dwordx4 v[236:239], v247, s[24:27], s34 offen offset:768 sc0 sc1
  v_exp_f32 v60, v60
  v_exp_f32 v57, v57
  v_exp_f32 v61, v61
  v_exp_f32 v58, v58
  v_exp_f32 v62, v62
  v_exp_f32 v59, v59
  v_exp_f32 v63, v63
  v_cvt_pk_bf16_f32 v24, v48, v49
  v_cvt_pk_bf16_f32 v25, v50, v51
  v_cvt_pk_bf16_f32 v26, v56, v57
  v_cvt_pk_bf16_f32 v27, v58, v59
  v_cvt_pk_bf16_f32 v28, v52, v53
  v_cvt_pk_bf16_f32 v29, v54, v55
  v_cvt_pk_bf16_f32 v30, v60, v61
  v_cvt_pk_bf16_f32 v31, v62, v63
  v_exp_f32 v64, v64
  v_exp_f32 v68, v68
  v_mul_f32_dpp v132, v253, v132 row_newbcast:0 row_mask:0xf bank_mask:0xf
  v_mul_f32_dpp v140, v253, v140 row_newbcast:0 row_mask:0xf bank_mask:0xf
  v_mul_f32_dpp v148, v253, v148 row_newbcast:0 row_mask:0xf bank_mask:0xf
  v_mul_f32_dpp v156, v253, v156 row_newbcast:0 row_mask:0xf bank_mask:0xf
  v_mul_f32_dpp v164, v253, v164 row_newbcast:0 row_mask:0xf bank_mask:0xf
  v_mul_f32_dpp v172, v253, v172 row_newbcast:0 row_mask:0xf bank_mask:0xf
  v_mul_f32_dpp v180, v253, v180 row_newbcast:0 row_mask:0xf bank_mask:0xf
  v_mul_f32_dpp v188, v253, v188 row_newbcast:0 row_mask:0xf bank_mask:0xf
  v_cvt_pk_bf16_f32 v224, v132, v140
  v_cvt_pk_bf16_f32 v225, v148, v156
  v_cvt_pk_bf16_f32 v226, v164, v172
  v_cvt_pk_bf16_f32 v227, v180, v188
  buffer_store_dwordx4 v[224:227], v247, s[24:27], s35 offen offset:0 sc0 sc1
  v_exp_f32 v65, v65
  v_exp_f32 v69, v69
  v_exp_f32 v66, v66
  v_exp_f32 v70, v70
  v_exp_f32 v67, v67
  v_exp_f32 v71, v71
  v_exp_f32 v72, v72
  v_exp_f32 v76, v76
  v_exp_f32 v73, v73
  v_exp_f32 v77, v77
  v_exp_f32 v74, v74
  v_exp_f32 v78, v78
  v_exp_f32 v75, v75
  v_exp_f32 v79, v79
  v_cvt_pk_bf16_f32 v32, v64, v65
  v_cvt_pk_bf16_f32 v33, v66, v67
  v_cvt_pk_bf16_f32 v34, v72, v73
  v_mul_f32_dpp v133, v253, v133 row_newbcast:1 row_mask:0xf bank_mask:0xf
  v_mul_f32_dpp v141, v253, v141 row_newbcast:1 row_mask:0xf bank_mask:0xf
  v_mul_f32_dpp v149, v253, v149 row_newbcast:1 row_mask:0xf bank_mask:0xf
  v_mul_f32_dpp v157, v253, v157 row_newbcast:1 row_mask:0xf bank_mask:0xf
  v_mul_f32_dpp v165, v253, v165 row_newbcast:1 row_mask:0xf bank_mask:0xf
  v_mul_f32_dpp v173, v253, v173 row_newbcast:1 row_mask:0xf bank_mask:0xf
  v_mul_f32_dpp v181, v253, v181 row_newbcast:1 row_mask:0xf bank_mask:0xf
  v_mul_f32_dpp v189, v253, v189 row_newbcast:1 row_mask:0xf bank_mask:0xf
  v_cvt_pk_bf16_f32 v228, v133, v141
  v_cvt_pk_bf16_f32 v229, v149, v157
  v_cvt_pk_bf16_f32 v230, v165, v173
  v_cvt_pk_bf16_f32 v231, v181, v189
  buffer_store_dwordx4 v[228:231], v247, s[24:27], s35 offen offset:256 sc0 sc1
  v_cvt_pk_bf16_f32 v35, v74, v75
  v_cvt_pk_bf16_f32 v36, v68, v69
  v_cvt_pk_bf16_f32 v37, v70, v71
  v_cvt_pk_bf16_f32 v38, v76, v77
  v_cvt_pk_bf16_f32 v39, v78, v79
  v_exp_f32 v80, v80
  v_exp_f32 v84, v84
  v_exp_f32 v81, v81
  v_exp_f32 v85, v85
  v_exp_f32 v82, v82
  v_exp_f32 v86, v86
  v_exp_f32 v83, v83
  v_exp_f32 v87, v87
  v_exp_f32 v88, v88
  v_exp_f32 v92, v92
  v_exp_f32 v89, v89
  v_exp_f32 v93, v93
  v_mul_f32_dpp v134, v253, v134 row_newbcast:2 row_mask:0xf bank_mask:0xf
  v_mul_f32_dpp v142, v253, v142 row_newbcast:2 row_mask:0xf bank_mask:0xf
  v_mul_f32_dpp v150, v253, v150 row_newbcast:2 row_mask:0xf bank_mask:0xf
  v_mul_f32_dpp v158, v253, v158 row_newbcast:2 row_mask:0xf bank_mask:0xf
  v_mul_f32_dpp v166, v253, v166 row_newbcast:2 row_mask:0xf bank_mask:0xf
  v_mul_f32_dpp v174, v253, v174 row_newbcast:2 row_mask:0xf bank_mask:0xf
  v_mul_f32_dpp v182, v253, v182 row_newbcast:2 row_mask:0xf bank_mask:0xf
  v_mul_f32_dpp v190, v253, v190 row_newbcast:2 row_mask:0xf bank_mask:0xf
  v_cvt_pk_bf16_f32 v232, v134, v142
  v_cvt_pk_bf16_f32 v233, v150, v158
  v_cvt_pk_bf16_f32 v234, v166, v174
  v_cvt_pk_bf16_f32 v235, v182, v190
  buffer_store_dwordx4 v[232:235], v247, s[24:27], s35 offen offset:512 sc0 sc1
  v_exp_f32 v90, v90
  v_exp_f32 v94, v94
  v_exp_f32 v91, v91
  v_exp_f32 v95, v95
  v_cvt_pk_bf16_f32 v40, v80, v81
  v_cvt_pk_bf16_f32 v41, v82, v83
  v_cvt_pk_bf16_f32 v42, v88, v89
  v_cvt_pk_bf16_f32 v43, v90, v91
  v_cvt_pk_bf16_f32 v44, v84, v85
  v_cvt_pk_bf16_f32 v45, v86, v87
  v_cvt_pk_bf16_f32 v46, v92, v93
  v_cvt_pk_bf16_f32 v47, v94, v95
  v_exp_f32 v96, v96
  v_exp_f32 v100, v100
  v_exp_f32 v97, v97
  v_exp_f32 v101, v101
  v_exp_f32 v98, v98
  v_mul_f32_dpp v135, v253, v135 row_newbcast:3 row_mask:0xf bank_mask:0xf
  v_mul_f32_dpp v143, v253, v143 row_newbcast:3 row_mask:0xf bank_mask:0xf
  v_mul_f32_dpp v151, v253, v151 row_newbcast:3 row_mask:0xf bank_mask:0xf
  v_mul_f32_dpp v159, v253, v159 row_newbcast:3 row_mask:0xf bank_mask:0xf
  v_mul_f32_dpp v167, v253, v167 row_newbcast:3 row_mask:0xf bank_mask:0xf
  v_mul_f32_dpp v175, v253, v175 row_newbcast:3 row_mask:0xf bank_mask:0xf
  v_mul_f32_dpp v183, v253, v183 row_newbcast:3 row_mask:0xf bank_mask:0xf
  v_mul_f32_dpp v191, v253, v191 row_newbcast:3 row_mask:0xf bank_mask:0xf
  v_cvt_pk_bf16_f32 v236, v135, v143
  v_cvt_pk_bf16_f32 v237, v151, v159
  v_cvt_pk_bf16_f32 v238, v167, v175
  v_cvt_pk_bf16_f32 v239, v183, v191
  buffer_store_dwordx4 v[236:239], v247, s[24:27], s35 offen offset:768 sc0 sc1
  v_exp_f32 v102, v102
  v_exp_f32 v99, v99
  v_exp_f32 v103, v103
  v_exp_f32 v104, v104
  v_exp_f32 v108, v108
  v_exp_f32 v105, v105
  v_exp_f32 v109, v109
  v_exp_f32 v106, v106
  v_exp_f32 v110, v110
  v_exp_f32 v107, v107
  v_exp_f32 v111, v111
  v_cvt_pk_bf16_f32 v48, v96, v97
  v_cvt_pk_bf16_f32 v49, v98, v99
  v_cvt_pk_bf16_f32 v50, v104, v105
  v_cvt_pk_bf16_f32 v51, v106, v107
  v_cvt_pk_bf16_f32 v52, v100, v101
  v_cvt_pk_bf16_f32 v53, v102, v103
  v_cvt_pk_bf16_f32 v54, v108, v109
  v_cvt_pk_bf16_f32 v55, v110, v111
  v_lshrrev_b32 v108, 6, v247
  v_bfe_i32 v107, v247, 4, 1
  v_xor_b32 v108, v108, v247
  v_and_b32 v107, 0xaaaaaaaa, v107
  v_bfe_i32 v108, v108, 5, 1
  v_xor_b32 v107, 0x44444444, v107
  v_and_b32 v108, 0x3f803f80, v108
  v_mov_b32 v109, v108
  v_mov_b32 v110, v108
  v_mov_b32 v111, v108
  v_mov_b32 v248, 0
  v_mov_b32 v249, 0
  v_mov_b32 v250, 0
  v_mov_b32 v251, 0
  s_waitcnt vmcnt(8)
  ds_read_b128 v[208:211], v245 offset:0
  ds_read_b128 v[212:215], v245 offset:2048
  ds_read_b128 v[216:219], v240 offset:0
  ds_read_b128 v[220:223], v240 offset:2048
  v_xor_b32 v96, 0x10000, v247
  v_xor_b32 v97, 0x10110, v247
  v_xor_b32 v98, 0x10220, v247
  v_xor_b32 v99, 0x10330, v247
  v_xor_b32 v100, 0x11040, v247
  v_xor_b32 v101, 0x11150, v247
  v_xor_b32 v102, 0x11260, v247
  v_xor_b32 v103, 0x11370, v247
  v_exp_f32 v112, v112
  v_exp_f32 v116, v116
  v_exp_f32 v113, v113
  v_exp_f32 v117, v117
  v_exp_f32 v114, v114
  v_exp_f32 v118, v118
  v_exp_f32 v115, v115
  v_exp_f32 v119, v119
  v_exp_f32 v120, v120
  s_add_u32 m0, s43, 0x0
  v_exp_f32 v124, v124
  s_waitcnt lgkmcnt(0)
  s_cmp_lt_u32 s41, 2
  s_cselect_b32 s14, 0x4000000, 0
  buffer_load_dwordx4 v246, s[12:15], s39 offen offset:0 nt lds
  v_exp_f32 v121, v121
  v_exp_f32 v125, v125
  v_exp_f32 v122, v122
  s_add_u32 m0, s43, 0xfffffc00
  v_exp_f32 v126, v126
  buffer_load_dwordx4 v241, s[12:15], s39 offen offset:2048 nt lds
  v_exp_f32 v123, v123
  v_exp_f32 v127, v127
  v_cvt_pk_bf16_f32 v56, v112, v113
  s_add_u32 m0, s43, 0x800
  v_cvt_pk_bf16_f32 v57, v114, v115
  buffer_load_dwordx4 v246, s[12:15], s40 offen offset:0 nt lds
  v_cvt_pk_bf16_f32 v58, v120, v121
  v_cvt_pk_bf16_f32 v59, v122, v123
  v_cvt_pk_bf16_f32 v60, v116, v117
  s_add_u32 m0, s43, 0x400
  v_cvt_pk_bf16_f32 v61, v118, v119
  buffer_load_dwordx4 v241, s[12:15], s40 offen offset:2048 nt lds
  v_cvt_pk_bf16_f32 v62, v124, v125
  v_cvt_pk_bf16_f32 v63, v126, v127
  v_xor_b32 v120, 64, v244
  v_xor_b32 v121, 128, v244
  v_xor_b32 v122, 192, v244
  s_mov_b32 s26, 0x4000000
  s_cmp_eq_u32 s41, s45
  s_cbranch_scc0 L_v
  s_barrier
L_v:
  ds_read_b128 v[64:67], v96 offset:0
  ds_read_b128 v[68:71], v96 offset:8192
  ds_read_b128 v[72:75], v96 offset:16384
  ds_read_b128 v[76:79], v96 offset:24576
  ds_read_b128 v[80:83], v96 offset:32768
  ds_read_b128 v[84:87], v96 offset:40960
  s_setprio 1
  s_cmp_eq_u32 s41, s9
  s_cbranch_scc1 L_pvnb
L_pv:
  s_barrier
L_pvnb:
  v_smfmac_f32_16x16x64_bf16 v[248:251], v[108:111], v[0:7], v107
  v_smfmac_f32_16x16x64_bf16 v[248:251], v[108:111], v[8:15], v107
  v_smfmac_f32_16x16x64_bf16 v[248:251], v[108:111], v[16:23], v107
  v_smfmac_f32_16x16x64_bf16 v[248:251], v[108:111], v[24:31], v107
  v_smfmac_f32_16x16x64_bf16 v[248:251], v[108:111], v[32:39], v107
  v_smfmac_f32_16x16x64_bf16 v[248:251], v[108:111], v[40:47], v107
  v_smfmac_f32_16x16x64_bf16 v[248:251], v[108:111], v[48:55], v107
  v_smfmac_f32_16x16x64_bf16 v[248:251], v[108:111], v[56:63], v107
  s_waitcnt lgkmcnt(5)
  v_mfma_f32_16x16x32_bf16 v[128:131], v[0:3], v[64:67], 0
  ds_read_b128 v[88:91], v96 offset:49152
  v_mfma_f32_16x16x32_bf16 v[132:135], v[4:7], v[64:67], 0
  s_waitcnt lgkmcnt(5)
  v_mfma_f32_16x16x32_bf16 v[128:131], v[8:11], v[68:71], v[128:131]
  ds_read_b128 v[92:95], v96 offset:57344
  v_mfma_f32_16x16x32_bf16 v[132:135], v[12:15], v[68:71], v[132:135]
  s_waitcnt lgkmcnt(5)
  v_mfma_f32_16x16x32_bf16 v[128:131], v[16:19], v[72:75], v[128:131]
  ds_read_b128 v[64:67], v97 offset:0
  v_mfma_f32_16x16x32_bf16 v[132:135], v[20:23], v[72:75], v[132:135]
  v_add_f32 v252, v250, v251
  s_waitcnt lgkmcnt(5)
  v_mfma_f32_16x16x32_bf16 v[128:131], v[24:27], v[76:79], v[128:131]
  ds_read_b128 v[68:71], v97 offset:8192
  v_mfma_f32_16x16x32_bf16 v[132:135], v[28:31], v[76:79], v[132:135]
  v_add_f32 v253, v248, v249
  s_waitcnt lgkmcnt(5)
  v_mfma_f32_16x16x32_bf16 v[128:131], v[32:35], v[80:83], v[128:131]
  ds_read_b128 v[72:75], v97 offset:16384
  v_mfma_f32_16x16x32_bf16 v[132:135], v[36:39], v[80:83], v[132:135]
  v_max_u32 v112, v252, v253
  s_waitcnt lgkmcnt(5)
  v_mfma_f32_16x16x32_bf16 v[128:131], v[40:43], v[84:87], v[128:131]
  ds_read_b128 v[76:79], v97 offset:24576
  v_mfma_f32_16x16x32_bf16 v[132:135], v[44:47], v[84:87], v[132:135]
  v_min_u32 v113, v252, v253
  s_waitcnt lgkmcnt(5)
  v_mfma_f32_16x16x32_bf16 v[128:131], v[48:51], v[88:91], v[128:131]
  ds_read_b128 v[80:83], v97 offset:32768
  v_mfma_f32_16x16x32_bf16 v[132:135], v[52:55], v[88:91], v[132:135]
  v_cmp_lt_u32 vcc, s47, v112
  s_waitcnt lgkmcnt(5)
  v_mfma_f32_16x16x32_bf16 v[128:131], v[56:59], v[92:95], v[128:131]
  ds_read_b128 v[84:87], v97 offset:40960
  v_mfma_f32_16x16x32_bf16 v[132:135], v[60:63], v[92:95], v[132:135]
  v_cmp_gt_u32 s[4:5], s46, v113
  s_waitcnt lgkmcnt(5)
  v_mfma_f32_16x16x32_bf16 v[136:139], v[0:3], v[64:67], 0
  ds_read_b128 v[88:91], v97 offset:49152
  v_mfma_f32_16x16x32_bf16 v[140:143], v[4:7], v[64:67], 0
  s_waitcnt lgkmcnt(5)
  v_mfma_f32_16x16x32_bf16 v[136:139], v[8:11], v[68:71], v[136:139]
  ds_read_b128 v[92:95], v97 offset:57344
  v_mfma_f32_16x16x32_bf16 v[140:143], v[12:15], v[68:71], v[140:143]
  s_waitcnt lgkmcnt(5)
  v_mfma_f32_16x16x32_bf16 v[136:139], v[16:19], v[72:75], v[136:139]
  ds_read_b128 v[64:67], v98 offset:0
  v_mfma_f32_16x16x32_bf16 v[140:143], v[20:23], v[72:75], v[140:143]
  s_waitcnt lgkmcnt(5)
  v_mfma_f32_16x16x32_bf16 v[136:139], v[24:27], v[76:79], v[136:139]
  ds_read_b128 v[68:71], v98 offset:8192
  v_mfma_f32_16x16x32_bf16 v[140:143], v[28:31], v[76:79], v[140:143]
  s_or_b64 s[4:5], vcc, s[4:5]
  s_waitcnt lgkmcnt(5)
  v_mfma_f32_16x16x32_bf16 v[136:139], v[32:35], v[80:83], v[136:139]
  ds_read_b128 v[72:75], v98 offset:16384
  v_mfma_f32_16x16x32_bf16 v[140:143], v[36:39], v[80:83], v[140:143]
  s_or_b64 vcc, s[4:5], s[6:7]
  s_waitcnt lgkmcnt(5)
  v_mfma_f32_16x16x32_bf16 v[136:139], v[40:43], v[84:87], v[136:139]
  ds_read_b128 v[76:79], v98 offset:24576
  v_mfma_f32_16x16x32_bf16 v[140:143], v[44:47], v[84:87], v[140:143]
  s_waitcnt lgkmcnt(5)
  v_mfma_f32_16x16x32_bf16 v[136:139], v[48:51], v[88:91], v[136:139]
  ds_read_b128 v[80:83], v98 offset:32768
  v_mfma_f32_16x16x32_bf16 v[140:143], v[52:55], v[88:91], v[140:143]
  s_waitcnt lgkmcnt(5)
  v_mfma_f32_16x16x32_bf16 v[136:139], v[56:59], v[92:95], v[136:139]
  ds_read_b128 v[84:87], v98 offset:40960
  v_mfma_f32_16x16x32_bf16 v[140:143], v[60:63], v[92:95], v[140:143]
  s_waitcnt lgkmcnt(5)
  v_mfma_f32_16x16x32_bf16 v[144:147], v[0:3], v[64:67], 0
  ds_read_b128 v[88:91], v98 offset:49152
  v_mfma_f32_16x16x32_bf16 v[148:151], v[4:7], v[64:67], 0
  s_waitcnt lgkmcnt(5)
  v_mfma_f32_16x16x32_bf16 v[144:147], v[8:11], v[68:71], v[144:147]
  ds_read_b128 v[92:95], v98 offset:57344
  v_mfma_f32_16x16x32_bf16 v[148:151], v[12:15], v[68:71], v[148:151]
  s_waitcnt lgkmcnt(5)
  v_mfma_f32_16x16x32_bf16 v[144:147], v[16:19], v[72:75], v[144:147]
  ds_read_b128 v[64:67], v99 offset:0
  v_mfma_f32_16x16x32_bf16 v[148:151], v[20:23], v[72:75], v[148:151]
  s_waitcnt lgkmcnt(5)
  v_mfma_f32_16x16x32_bf16 v[144:147], v[24:27], v[76:79], v[144:147]
  ds_read_b128 v[68:71], v99 offset:8192
  v_mfma_f32_16x16x32_bf16 v[148:151], v[28:31], v[76:79], v[148:151]
  s_waitcnt lgkmcnt(5)
  v_mfma_f32_16x16x32_bf16 v[144:147], v[32:35], v[80:83], v[144:147]
  ds_read_b128 v[72:75], v99 offset:16384
  v_mfma_f32_16x16x32_bf16 v[148:151], v[36:39], v[80:83], v[148:151]
  s_waitcnt lgkmcnt(5)
  v_mfma_f32_16x16x32_bf16 v[144:147], v[40:43], v[84:87], v[144:147]
  ds_read_b128 v[76:79], v99 offset:24576
  v_mfma_f32_16x16x32_bf16 v[148:151], v[44:47], v[84:87], v[148:151]
  s_waitcnt lgkmcnt(5)
  v_mfma_f32_16x16x32_bf16 v[144:147], v[48:51], v[88:91], v[144:147]
  ds_read_b128 v[80:83], v99 offset:32768
  v_mfma_f32_16x16x32_bf16 v[148:151], v[52:55], v[88:91], v[148:151]
  s_waitcnt lgkmcnt(5)
  v_mfma_f32_16x16x32_bf16 v[144:147], v[56:59], v[92:95], v[144:147]
  ds_read_b128 v[84:87], v99 offset:40960
  v_mfma_f32_16x16x32_bf16 v[148:151], v[60:63], v[92:95], v[148:151]
  s_waitcnt lgkmcnt(5)
  v_mfma_f32_16x16x32_bf16 v[152:155], v[0:3], v[64:67], 0
  ds_read_b128 v[88:91], v99 offset:49152
  v_mfma_f32_16x16x32_bf16 v[156:159], v[4:7], v[64:67], 0
  s_waitcnt lgkmcnt(5)
  v_mfma_f32_16x16x32_bf16 v[152:155], v[8:11], v[68:71], v[152:155]
  ds_read_b128 v[92:95], v99 offset:57344
  v_mfma_f32_16x16x32_bf16 v[156:159], v[12:15], v[68:71], v[156:159]
  s_waitcnt lgkmcnt(5)
  v_mfma_f32_16x16x32_bf16 v[152:155], v[16:19], v[72:75], v[152:155]
  ds_read_b128 v[64:67], v100 offset:0
  v_mfma_f32_16x16x32_bf16 v[156:159], v[20:23], v[72:75], v[156:159]
  s_waitcnt lgkmcnt(5)
  v_mfma_f32_16x16x32_bf16 v[152:155], v[24:27], v[76:79], v[152:155]
  ds_read_b128 v[68:71], v100 offset:8192
  v_mfma_f32_16x16x32_bf16 v[156:159], v[28:31], v[76:79], v[156:159]
  s_waitcnt lgkmcnt(5)
  v_mfma_f32_16x16x32_bf16 v[152:155], v[32:35], v[80:83], v[152:155]
  ds_read_b128 v[72:75], v100 offset:16384
  v_mfma_f32_16x16x32_bf16 v[156:159], v[36:39], v[80:83], v[156:159]
  s_waitcnt lgkmcnt(5)
  v_mfma_f32_16x16x32_bf16 v[152:155], v[40:43], v[84:87], v[152:155]
  ds_read_b128 v[76:79], v100 offset:24576
  v_mfma_f32_16x16x32_bf16 v[156:159], v[44:47], v[84:87], v[156:159]
  s_waitcnt lgkmcnt(5)
  v_mfma_f32_16x16x32_bf16 v[152:155], v[48:51], v[88:91], v[152:155]
  ds_read_b128 v[80:83], v100 offset:32768
  v_mfma_f32_16x16x32_bf16 v[156:159], v[52:55], v[88:91], v[156:159]
  s_waitcnt lgkmcnt(5)
  v_mfma_f32_16x16x32_bf16 v[152:155], v[56:59], v[92:95], v[152:155]
  ds_read_b128 v[84:87], v100 offset:40960
  v_mfma_f32_16x16x32_bf16 v[156:159], v[60:63], v[92:95], v[156:159]
  s_waitcnt lgkmcnt(5)
  v_mfma_f32_16x16x32_bf16 v[160:163], v[0:3], v[64:67], 0
  ds_read_b128 v[88:91], v100 offset:49152
  v_mfma_f32_16x16x32_bf16 v[164:167], v[4:7], v[64:67], 0
  s_waitcnt lgkmcnt(5)
  v_mfma_f32_16x16x32_bf16 v[160:163], v[8:11], v[68:71], v[160:163]
  ds_read_b128 v[92:95], v100 offset:57344
  v_mfma_f32_16x16x32_bf16 v[164:167], v[12:15], v[68:71], v[164:167]
  s_waitcnt lgkmcnt(5)
  v_mfma_f32_16x16x32_bf16 v[160:163], v[16:19], v[72:75], v[160:163]
  ds_read_b128 v[64:67], v101 offset:0
  v_mfma_f32_16x16x32_bf16 v[164:167], v[20:23], v[72:75], v[164:167]
  s_waitcnt lgkmcnt(5)
  v_mfma_f32_16x16x32_bf16 v[160:163], v[24:27], v[76:79], v[160:163]
  ds_read_b128 v[68:71], v101 offset:8192
  v_mfma_f32_16x16x32_bf16 v[164:167], v[28:31], v[76:79], v[164:167]
  s_waitcnt lgkmcnt(5)
  v_mfma_f32_16x16x32_bf16 v[160:163], v[32:35], v[80:83], v[160:163]
  ds_read_b128 v[72:75], v101 offset:16384
  v_mfma_f32_16x16x32_bf16 v[164:167], v[36:39], v[80:83], v[164:167]
  s_waitcnt lgkmcnt(5)
  v_mfma_f32_16x16x32_bf16 v[160:163], v[40:43], v[84:87], v[160:163]
  ds_read_b128 v[76:79], v101 offset:24576
  v_mfma_f32_16x16x32_bf16 v[164:167], v[44:47], v[84:87], v[164:167]
  s_waitcnt lgkmcnt(5)
  v_mfma_f32_16x16x32_bf16 v[160:163], v[48:51], v[88:91], v[160:163]
  ds_read_b128 v[80:83], v101 offset:32768
  v_mfma_f32_16x16x32_bf16 v[164:167], v[52:55], v[88:91], v[164:167]
  s_waitcnt lgkmcnt(5)
  v_mfma_f32_16x16x32_bf16 v[160:163], v[56:59], v[92:95], v[160:163]
  ds_read_b128 v[84:87], v101 offset:40960
  v_mfma_f32_16x16x32_bf16 v[164:167], v[60:63], v[92:95], v[164:167]
  s_waitcnt lgkmcnt(5)
  v_mfma_f32_16x16x32_bf16 v[168:171], v[0:3], v[64:67], 0
  ds_read_b128 v[88:91], v101 offset:49152
  v_mfma_f32_16x16x32_bf16 v[172:175], v[4:7], v[64:67], 0
  s_waitcnt lgkmcnt(5)
  v_mfma_f32_16x16x32_bf16 v[168:171], v[8:11], v[68:71], v[168:171]
  ds_read_b128 v[92:95], v101 offset:57344
  v_mfma_f32_16x16x32_bf16 v[172:175], v[12:15], v[68:71], v[172:175]
  s_waitcnt lgkmcnt(5)
  v_mfma_f32_16x16x32_bf16 v[168:171], v[16:19], v[72:75], v[168:171]
  ds_read_b128 v[64:67], v102 offset:0
  v_mfma_f32_16x16x32_bf16 v[172:175], v[20:23], v[72:75], v[172:175]
  s_waitcnt lgkmcnt(5)
  v_mfma_f32_16x16x32_bf16 v[168:171], v[24:27], v[76:79], v[168:171]
  ds_read_b128 v[68:71], v102 offset:8192
  v_mfma_f32_16x16x32_bf16 v[172:175], v[28:31], v[76:79], v[172:175]
  s_waitcnt lgkmcnt(5)
  v_mfma_f32_16x16x32_bf16 v[168:171], v[32:35], v[80:83], v[168:171]
  ds_read_b128 v[72:75], v102 offset:16384
  v_mfma_f32_16x16x32_bf16 v[172:175], v[36:39], v[80:83], v[172:175]
  s_waitcnt lgkmcnt(5)
  v_mfma_f32_16x16x32_bf16 v[168:171], v[40:43], v[84:87], v[168:171]
  ds_read_b128 v[76:79], v102 offset:24576
  v_mfma_f32_16x16x32_bf16 v[172:175], v[44:47], v[84:87], v[172:175]
  s_waitcnt lgkmcnt(5)
  v_mfma_f32_16x16x32_bf16 v[168:171], v[48:51], v[88:91], v[168:171]
  ds_read_b128 v[80:83], v102 offset:32768
  v_mfma_f32_16x16x32_bf16 v[172:175], v[52:55], v[88:91], v[172:175]
  s_waitcnt lgkmcnt(5)
  v_mfma_f32_16x16x32_bf16 v[168:171], v[56:59], v[92:95], v[168:171]
  ds_read_b128 v[84:87], v102 offset:40960
  v_mfma_f32_16x16x32_bf16 v[172:175], v[60:63], v[92:95], v[172:175]
  s_waitcnt lgkmcnt(5)
  v_mfma_f32_16x16x32_bf16 v[176:179], v[0:3], v[64:67], 0
  ds_read_b128 v[88:91], v102 offset:49152
  v_mfma_f32_16x16x32_bf16 v[180:183], v[4:7], v[64:67], 0
  s_waitcnt lgkmcnt(5)
  v_mfma_f32_16x16x32_bf16 v[176:179], v[8:11], v[68:71], v[176:179]
  ds_read_b128 v[92:95], v102 offset:57344
  v_mfma_f32_16x16x32_bf16 v[180:183], v[12:15], v[68:71], v[180:183]
  s_waitcnt lgkmcnt(5)
  v_mfma_f32_16x16x32_bf16 v[176:179], v[16:19], v[72:75], v[176:179]
  ds_read_b128 v[64:67], v103 offset:0
  v_mfma_f32_16x16x32_bf16 v[180:183], v[20:23], v[72:75], v[180:183]
  s_waitcnt lgkmcnt(5)
  v_mfma_f32_16x16x32_bf16 v[176:179], v[24:27], v[76:79], v[176:179]
  ds_read_b128 v[68:71], v103 offset:8192
  v_mfma_f32_16x16x32_bf16 v[180:183], v[28:31], v[76:79], v[180:183]
  s_waitcnt lgkmcnt(5)
  v_mfma_f32_16x16x32_bf16 v[176:179], v[32:35], v[80:83], v[176:179]
  ds_read_b128 v[72:75], v103 offset:16384
  v_mfma_f32_16x16x32_bf16 v[180:183], v[36:39], v[80:83], v[180:183]
  s_waitcnt lgkmcnt(5)
  v_mfma_f32_16x16x32_bf16 v[176:179], v[40:43], v[84:87], v[176:179]
  ds_read_b128 v[76:79], v103 offset:24576
  v_mfma_f32_16x16x32_bf16 v[180:183], v[44:47], v[84:87], v[180:183]
  s_waitcnt lgkmcnt(5)
  v_mfma_f32_16x16x32_bf16 v[176:179], v[48:51], v[88:91], v[176:179]
  ds_read_b128 v[80:83], v103 offset:32768
  v_mfma_f32_16x16x32_bf16 v[180:183], v[52:55], v[88:91], v[180:183]
  s_waitcnt lgkmcnt(5)
  v_mfma_f32_16x16x32_bf16 v[176:179], v[56:59], v[92:95], v[176:179]
  ds_read_b128 v[84:87], v103 offset:40960
  v_mfma_f32_16x16x32_bf16 v[180:183], v[60:63], v[92:95], v[180:183]
  s_waitcnt lgkmcnt(5)
  v_mfma_f32_16x16x32_bf16 v[184:187], v[0:3], v[64:67], 0
  ds_read_b128 v[88:91], v103 offset:49152
  v_mfma_f32_16x16x32_bf16 v[188:191], v[4:7], v[64:67], 0
  s_waitcnt lgkmcnt(5)
  v_mfma_f32_16x16x32_bf16 v[184:187], v[8:11], v[68:71], v[184:187]
  ds_read_b128 v[92:95], v103 offset:57344
  v_mfma_f32_16x16x32_bf16 v[188:191], v[12:15], v[68:71], v[188:191]
  s_waitcnt lgkmcnt(5)
  v_mfma_f32_16x16x32_bf16 v[184:187], v[16:19], v[72:75], v[184:187]
  v_mfma_f32_16x16x32_bf16 v[188:191], v[20:23], v[72:75], v[188:191]
  s_waitcnt lgkmcnt(4)
  v_mfma_f32_16x16x32_bf16 v[184:187], v[24:27], v[76:79], v[184:187]
  v_mfma_f32_16x16x32_bf16 v[188:191], v[28:31], v[76:79], v[188:191]
  s_waitcnt lgkmcnt(3)
  v_mfma_f32_16x16x32_bf16 v[184:187], v[32:35], v[80:83], v[184:187]
  v_mfma_f32_16x16x32_bf16 v[188:191], v[36:39], v[80:83], v[188:191]
  ds_read_b128 v[224:227], v244 offset:0
  s_waitcnt lgkmcnt(3)
  v_mfma_f32_16x16x32_bf16 v[184:187], v[40:43], v[84:87], v[184:187]
  v_mfma_f32_16x16x32_bf16 v[188:191], v[44:47], v[84:87], v[188:191]
  ds_read_b128 v[228:231], v120 offset:0
  s_waitcnt lgkmcnt(3)
  v_mfma_f32_16x16x32_bf16 v[184:187], v[48:51], v[88:91], v[184:187]
  v_mfma_f32_16x16x32_bf16 v[188:191], v[52:55], v[88:91], v[188:191]
  ds_read_b128 v[232:235], v121 offset:0
  s_waitcnt lgkmcnt(3)
  v_mfma_f32_16x16x32_bf16 v[184:187], v[56:59], v[92:95], v[184:187]
  v_mfma_f32_16x16x32_bf16 v[188:191], v[60:63], v[92:95], v[188:191]
  ds_read_b128 v[236:239], v122 offset:0
  s_cbranch_vccz L_cont
L_rare:
  s_cmp_lg_u64 s[4:5], 0
  s_cbranch_scc1 L_fb
L_fb_ret:
  s_cmp_eq_u32 s41, 3
  s_cbranch_scc1 L_tail
  s_cmp_eq_u32 s41, s45
  s_cbranch_scc0 L_cont
  v_xor_b32 v240, 64, v245
  v_xor_b32 v241, 64, v246
  s_waitcnt vmcnt(0)
  ds_read_b128 v[192:195], v245 offset:0
  ds_read_b128 v[196:199], v245 offset:2048
  ds_read_b128 v[200:203], v240 offset:0
  ds_read_b128 v[204:207], v240 offset:2048
  s_mov_b32 s54, 0x20000
  s_add_u32 s39, s32, 0x20000
  s_add_u32 s40, s33, 0x20000
  s_waitcnt lgkmcnt(0)
  s_add_u32 m0, s43, 0x0
  s_nop 0
  buffer_load_dwordx4 v246, s[12:15], s39 offen offset:0 nt lds
  s_add_u32 m0, s43, 0xfffffc00
  s_nop 0
  buffer_load_dwordx4 v241, s[12:15], s39 offen offset:2048 nt lds
  s_add_u32 m0, s43, 0x800
  s_nop 0
  buffer_load_dwordx4 v246, s[12:15], s40 offen offset:0 nt lds
  s_add_u32 m0, s43, 0x400
  s_nop 0
  buffer_load_dwordx4 v241, s[12:15], s40 offen offset:2048 nt lds
  s_branch L_cont
L_tail:
  s_setprio 0
  v_rcp_f32 v252, v252
  v_rcp_f32 v253, v253
  s_nop 0
  v_mov_b32_dpp v252, v252 row_ror:12 row_mask:0x2 bank_mask:0xf
  v_mov_b32_dpp v253, v253 row_ror:12 row_mask:0x2 bank_mask:0xf
  s_nop 0
  v_mov_b32_dpp v252, v252 row_ror:8 row_mask:0x4 bank_mask:0xf
  v_mov_b32_dpp v253, v253 row_ror:8 row_mask:0x4 bank_mask:0xf
  s_nop 0
  v_mov_b32_dpp v252, v252 row_ror:4 row_mask:0x8 bank_mask:0xf
  v_mov_b32_dpp v253, v253 row_ror:4 row_mask:0x8 bank_mask:0xf
  s_nop 0
  v_mul_f32_dpp v128, v252, v128 row_newbcast:0 row_mask:0xf bank_mask:0xf
  v_mul_f32_dpp v136, v252, v136 row_newbcast:0 row_mask:0xf bank_mask:0xf
  v_mul_f32_dpp v144, v252, v144 row_newbcast:0 row_mask:0xf bank_mask:0xf
  v_mul_f32_dpp v152, v252, v152 row_newbcast:0 row_mask:0xf bank_mask:0xf
  v_mul_f32_dpp v160, v252, v160 row_newbcast:0 row_mask:0xf bank_mask:0xf
  v_mul_f32_dpp v168, v252, v168 row_newbcast:0 row_mask:0xf bank_mask:0xf
  v_mul_f32_dpp v176, v252, v176 row_newbcast:0 row_mask:0xf bank_mask:0xf
  v_mul_f32_dpp v184, v252, v184 row_newbcast:0 row_mask:0xf bank_mask:0xf
  v_cvt_pk_bf16_f32 v64, v128, v136
  v_cvt_pk_bf16_f32 v65, v144, v152
  v_cvt_pk_bf16_f32 v66, v160, v168
  v_cvt_pk_bf16_f32 v67, v176, v184
  buffer_store_dwordx4 v[64:67], v247, s[24:27], s32 offen offset:0 sc0 sc1
  v_mul_f32_dpp v129, v252, v129 row_newbcast:1 row_mask:0xf bank_mask:0xf
  v_mul_f32_dpp v137, v252, v137 row_newbcast:1 row_mask:0xf bank_mask:0xf
  v_mul_f32_dpp v145, v252, v145 row_newbcast:1 row_mask:0xf bank_mask:0xf
  v_mul_f32_dpp v153, v252, v153 row_newbcast:1 row_mask:0xf bank_mask:0xf
  v_mul_f32_dpp v161, v252, v161 row_newbcast:1 row_mask:0xf bank_mask:0xf
  v_mul_f32_dpp v169, v252, v169 row_newbcast:1 row_mask:0xf bank_mask:0xf
  v_mul_f32_dpp v177, v252, v177 row_newbcast:1 row_mask:0xf bank_mask:0xf
  v_mul_f32_dpp v185, v252, v185 row_newbcast:1 row_mask:0xf bank_mask:0xf
  v_cvt_pk_bf16_f32 v68, v129, v137
  v_cvt_pk_bf16_f32 v69, v145, v153
  v_cvt_pk_bf16_f32 v70, v161, v169
  v_cvt_pk_bf16_f32 v71, v177, v185
  buffer_store_dwordx4 v[68:71], v247, s[24:27], s32 offen offset:256 sc0 sc1
  v_mul_f32_dpp v130, v252, v130 row_newbcast:2 row_mask:0xf bank_mask:0xf
  v_mul_f32_dpp v138, v252, v138 row_newbcast:2 row_mask:0xf bank_mask:0xf
  v_mul_f32_dpp v146, v252, v146 row_newbcast:2 row_mask:0xf bank_mask:0xf
  v_mul_f32_dpp v154, v252, v154 row_newbcast:2 row_mask:0xf bank_mask:0xf
  v_mul_f32_dpp v162, v252, v162 row_newbcast:2 row_mask:0xf bank_mask:0xf
  v_mul_f32_dpp v170, v252, v170 row_newbcast:2 row_mask:0xf bank_mask:0xf
  v_mul_f32_dpp v178, v252, v178 row_newbcast:2 row_mask:0xf bank_mask:0xf
  v_mul_f32_dpp v186, v252, v186 row_newbcast:2 row_mask:0xf bank_mask:0xf
  v_cvt_pk_bf16_f32 v72, v130, v138
  v_cvt_pk_bf16_f32 v73, v146, v154
  v_cvt_pk_bf16_f32 v74, v162, v170
  v_cvt_pk_bf16_f32 v75, v178, v186
  buffer_store_dwordx4 v[72:75], v247, s[24:27], s32 offen offset:512 sc0 sc1
  v_mul_f32_dpp v131, v252, v131 row_newbcast:3 row_mask:0xf bank_mask:0xf
  v_mul_f32_dpp v139, v252, v139 row_newbcast:3 row_mask:0xf bank_mask:0xf
  v_mul_f32_dpp v147, v252, v147 row_newbcast:3 row_mask:0xf bank_mask:0xf
  v_mul_f32_dpp v155, v252, v155 row_newbcast:3 row_mask:0xf bank_mask:0xf
  v_mul_f32_dpp v163, v252, v163 row_newbcast:3 row_mask:0xf bank_mask:0xf
  v_mul_f32_dpp v171, v252, v171 row_newbcast:3 row_mask:0xf bank_mask:0xf
  v_mul_f32_dpp v179, v252, v179 row_newbcast:3 row_mask:0xf bank_mask:0xf
  v_mul_f32_dpp v187, v252, v187 row_newbcast:3 row_mask:0xf bank_mask:0xf
  v_cvt_pk_bf16_f32 v76, v131, v139
  v_cvt_pk_bf16_f32 v77, v147, v155
  v_cvt_pk_bf16_f32 v78, v163, v171
  v_cvt_pk_bf16_f32 v79, v179, v187
  buffer_store_dwordx4 v[76:79], v247, s[24:27], s32 offen offset:768 sc0 sc1
  v_mul_f32_dpp v132, v253, v132 row_newbcast:0 row_mask:0xf bank_mask:0xf
  v_mul_f32_dpp v140, v253, v140 row_newbcast:0 row_mask:0xf bank_mask:0xf
  v_mul_f32_dpp v148, v253, v148 row_newbcast:0 row_mask:0xf bank_mask:0xf
  v_mul_f32_dpp v156, v253, v156 row_newbcast:0 row_mask:0xf bank_mask:0xf
  v_mul_f32_dpp v164, v253, v164 row_newbcast:0 row_mask:0xf bank_mask:0xf
  v_mul_f32_dpp v172, v253, v172 row_newbcast:0 row_mask:0xf bank_mask:0xf
  v_mul_f32_dpp v180, v253, v180 row_newbcast:0 row_mask:0xf bank_mask:0xf
  v_mul_f32_dpp v188, v253, v188 row_newbcast:0 row_mask:0xf bank_mask:0xf
  v_cvt_pk_bf16_f32 v64, v132, v140
  v_cvt_pk_bf16_f32 v65, v148, v156
  v_cvt_pk_bf16_f32 v66, v164, v172
  v_cvt_pk_bf16_f32 v67, v180, v188
  buffer_store_dwordx4 v[64:67], v247, s[24:27], s33 offen offset:0 sc0 sc1
  v_mul_f32_dpp v133, v253, v133 row_newbcast:1 row_mask:0xf bank_mask:0xf
  v_mul_f32_dpp v141, v253, v141 row_newbcast:1 row_mask:0xf bank_mask:0xf
  v_mul_f32_dpp v149, v253, v149 row_newbcast:1 row_mask:0xf bank_mask:0xf
  v_mul_f32_dpp v157, v253, v157 row_newbcast:1 row_mask:0xf bank_mask:0xf
  v_mul_f32_dpp v165, v253, v165 row_newbcast:1 row_mask:0xf bank_mask:0xf
  v_mul_f32_dpp v173, v253, v173 row_newbcast:1 row_mask:0xf bank_mask:0xf
  v_mul_f32_dpp v181, v253, v181 row_newbcast:1 row_mask:0xf bank_mask:0xf
  v_mul_f32_dpp v189, v253, v189 row_newbcast:1 row_mask:0xf bank_mask:0xf
  v_cvt_pk_bf16_f32 v68, v133, v141
  v_cvt_pk_bf16_f32 v69, v149, v157
  v_cvt_pk_bf16_f32 v70, v165, v173
  v_cvt_pk_bf16_f32 v71, v181, v189
  buffer_store_dwordx4 v[68:71], v247, s[24:27], s33 offen offset:256 sc0 sc1
  v_mul_f32_dpp v134, v253, v134 row_newbcast:2 row_mask:0xf bank_mask:0xf
  v_mul_f32_dpp v142, v253, v142 row_newbcast:2 row_mask:0xf bank_mask:0xf
  v_mul_f32_dpp v150, v253, v150 row_newbcast:2 row_mask:0xf bank_mask:0xf
  v_mul_f32_dpp v158, v253, v158 row_newbcast:2 row_mask:0xf bank_mask:0xf
  v_mul_f32_dpp v166, v253, v166 row_newbcast:2 row_mask:0xf bank_mask:0xf
  v_mul_f32_dpp v174, v253, v174 row_newbcast:2 row_mask:0xf bank_mask:0xf
  v_mul_f32_dpp v182, v253, v182 row_newbcast:2 row_mask:0xf bank_mask:0xf
  v_mul_f32_dpp v190, v253, v190 row_newbcast:2 row_mask:0xf bank_mask:0xf
  v_cvt_pk_bf16_f32 v72, v134, v142
  v_cvt_pk_bf16_f32 v73, v150, v158
  v_cvt_pk_bf16_f32 v74, v166, v174
  v_cvt_pk_bf16_f32 v75, v182, v190
  buffer_store_dwordx4 v[72:75], v247, s[24:27], s33 offen offset:512 sc0 sc1
  v_mul_f32_dpp v135, v253, v135 row_newbcast:3 row_mask:0xf bank_mask:0xf
  v_mul_f32_dpp v143, v253, v143 row_newbcast:3 row_mask:0xf bank_mask:0xf
  v_mul_f32_dpp v151, v253, v151 row_newbcast:3 row_mask:0xf bank_mask:0xf
  v_mul_f32_dpp v159, v253, v159 row_newbcast:3 row_mask:0xf bank_mask:0xf
  v_mul_f32_dpp v167, v253, v167 row_newbcast:3 row_mask:0xf bank_mask:0xf
  v_mul_f32_dpp v175, v253, v175 row_newbcast:3 row_mask:0xf bank_mask:0xf
  v_mul_f32_dpp v183, v253, v183 row_newbcast:3 row_mask:0xf bank_mask:0xf
  v_mul_f32_dpp v191, v253, v191 row_newbcast:3 row_mask:0xf bank_mask:0xf
  v_cvt_pk_bf16_f32 v76, v135, v143
  v_cvt_pk_bf16_f32 v77, v151, v159
  v_cvt_pk_bf16_f32 v78, v167, v175
  v_cvt_pk_bf16_f32 v79, v183, v191
  buffer_store_dwordx4 v[76:79], v247, s[24:27], s33 offen offset:768 sc0 sc1
L_end:
  s_endpgm
L_fb:
  s_waitcnt vmcnt(0) lgkmcnt(0)
  s_nop 15
  s_mov_b32 s14, 0x4000000
  v_xor_b32 v104, 64, v245
  v_xor_b32 v105, 64, v246
  s_add_u32 m0, s43, 0x0
  s_nop 0
  buffer_load_dwordx4 v246, s[12:15], s32 offen offset:0 nt lds
  s_add_u32 m0, s43, 0xfffffc00
  s_nop 0
  buffer_load_dwordx4 v105, s[12:15], s32 offen offset:2048 nt lds
  s_add_u32 m0, s43, 0x800
  s_nop 0
  buffer_load_dwordx4 v246, s[12:15], s33 offen offset:0 nt lds
  s_add_u32 m0, s43, 0x400
  s_nop 0
  buffer_load_dwordx4 v105, s[12:15], s33 offen offset:2048 nt lds
  s_waitcnt vmcnt(0)
  ds_read_b128 v[192:195], v245 offset:0
  ds_read_b128 v[196:199], v245 offset:2048
  ds_read_b128 v[200:203], v104 offset:0
  ds_read_b128 v[204:207], v104 offset:2048
  s_waitcnt lgkmcnt(0)
  v_xor_b32 v105, 64, v246
  s_add_u32 m0, s43, 0xffffff80
  s_nop 0
  buffer_load_dwordx4 v246, s[12:15], s32 offen offset:128 nt lds
  s_add_u32 m0, s43, 0xfffffb80
  s_nop 0
  buffer_load_dwordx4 v105, s[12:15], s32 offen offset:2176 nt lds
  s_add_u32 m0, s43, 0x780
  s_nop 0
  buffer_load_dwordx4 v246, s[12:15], s33 offen offset:128 nt lds
  s_add_u32 m0, s43, 0x380
  s_nop 0
  buffer_load_dwordx4 v105, s[12:15], s33 offen offset:2176 nt lds
  s_waitcnt vmcnt(0)
  ds_read_b128 v[208:211], v245 offset:0
  ds_read_b128 v[212:215], v245 offset:2048
  ds_read_b128 v[216:219], v104 offset:0
  ds_read_b128 v[220:223], v104 offset:2048
  s_waitcnt lgkmcnt(0)
  v_xor_b32 v120, 64, v244
  v_xor_b32 v121, 128, v244
  v_xor_b32 v122, 192, v244
  ds_read_b128 v[224:227], v244 offset:0
  ds_read_b128 v[228:231], v120 offset:0
  ds_read_b128 v[232:235], v121 offset:0
  ds_read_b128 v[236:239], v122 offset:0
  s_waitcnt lgkmcnt(3)
  v_mfma_f32_16x16x32_bf16 v[0:3], v[224:227], v[192:195], 0
  ds_read_b128 v[240:243], v244 offset:4096
  v_mfma_f32_16x16x32_bf16 v[4:7], v[224:227], v[196:199], 0
  s_waitcnt lgkmcnt(3)
  v_mfma_f32_16x16x32_bf16 v[0:3], v[228:231], v[200:203], v[0:3]
  ds_read_b128 v[224:227], v120 offset:4096
  v_mfma_f32_16x16x32_bf16 v[4:7], v[228:231], v[204:207], v[4:7]
  s_waitcnt lgkmcnt(3)
  v_mfma_f32_16x16x32_bf16 v[0:3], v[232:235], v[208:211], v[0:3]
  ds_read_b128 v[228:231], v121 offset:4096
  v_mfma_f32_16x16x32_bf16 v[4:7], v[232:235], v[212:215], v[4:7]
  s_waitcnt lgkmcnt(3)
  v_mfma_f32_16x16x32_bf16 v[0:3], v[236:239], v[216:219], v[0:3]
  ds_read_b128 v[232:235], v122 offset:4096
  v_mfma_f32_16x16x32_bf16 v[4:7], v[236:239], v[220:223], v[4:7]
  s_waitcnt lgkmcnt(3)
  v_mfma_f32_16x16x32_bf16 v[8:11], v[240:243], v[192:195], 0
  ds_read_b128 v[236:239], v244 offset:8192
  v_mfma_f32_16x16x32_bf16 v[12:15], v[240:243], v[196:199], 0
  s_waitcnt lgkmcnt(3)
  v_mfma_f32_16x16x32_bf16 v[8:11], v[224:227], v[200:203], v[8:11]
  ds_read_b128 v[240:243], v120 offset:8192
  v_mfma_f32_16x16x32_bf16 v[12:15], v[224:227], v[204:207], v[12:15]
  s_waitcnt lgkmcnt(3)
  v_mfma_f32_16x16x32_bf16 v[8:11], v[228:231], v[208:211], v[8:11]
  ds_read_b128 v[224:227], v121 offset:8192
  v_mfma_f32_16x16x32_bf16 v[12:15], v[228:231], v[212:215], v[12:15]
  s_waitcnt lgkmcnt(3)
  v_mfma_f32_16x16x32_bf16 v[8:11], v[232:235], v[216:219], v[8:11]
  ds_read_b128 v[228:231], v122 offset:8192
  v_mfma_f32_16x16x32_bf16 v[12:15], v[232:235], v[220:223], v[12:15]
  s_waitcnt lgkmcnt(3)
  v_mfma_f32_16x16x32_bf16 v[16:19], v[236:239], v[192:195], 0
  ds_read_b128 v[232:235], v244 offset:12288
  v_mfma_f32_16x16x32_bf16 v[20:23], v[236:239], v[196:199], 0
  s_waitcnt lgkmcnt(3)
  v_mfma_f32_16x16x32_bf16 v[16:19], v[240:243], v[200:203], v[16:19]
  ds_read_b128 v[236:239], v120 offset:12288
  v_mfma_f32_16x16x32_bf16 v[20:23], v[240:243], v[204:207], v[20:23]
  s_waitcnt lgkmcnt(3)
  v_mfma_f32_16x16x32_bf16 v[16:19], v[224:227], v[208:211], v[16:19]
  ds_read_b128 v[240:243], v121 offset:12288
  v_mfma_f32_16x16x32_bf16 v[20:23], v[224:227], v[212:215], v[20:23]
  s_waitcnt lgkmcnt(3)
  v_mfma_f32_16x16x32_bf16 v[16:19], v[228:231], v[216:219], v[16:19]
  ds_read_b128 v[224:227], v122 offset:12288
  v_mfma_f32_16x16x32_bf16 v[20:23], v[228:231], v[220:223], v[20:23]
  s_waitcnt lgkmcnt(3)
  v_mfma_f32_16x16x32_bf16 v[24:27], v[232:235], v[192:195], 0
  ds_read_b128 v[228:231], v244 offset:16384
  v_mfma_f32_16x16x32_bf16 v[28:31], v[232:235], v[196:199], 0
  s_waitcnt lgkmcnt(3)
  v_mfma_f32_16x16x32_bf16 v[24:27], v[236:239], v[200:203], v[24:27]
  ds_read_b128 v[232:235], v120 offset:16384
  v_mfma_f32_16x16x32_bf16 v[28:31], v[236:239], v[204:207], v[28:31]
  s_waitcnt lgkmcnt(3)
  v_mfma_f32_16x16x32_bf16 v[24:27], v[240:243], v[208:211], v[24:27]
  ds_read_b128 v[236:239], v121 offset:16384
  v_mfma_f32_16x16x32_bf16 v[28:31], v[240:243], v[212:215], v[28:31]
  s_waitcnt lgkmcnt(3)
  v_mfma_f32_16x16x32_bf16 v[24:27], v[224:227], v[216:219], v[24:27]
  ds_read_b128 v[240:243], v122 offset:16384
  v_mfma_f32_16x16x32_bf16 v[28:31], v[224:227], v[220:223], v[28:31]
  s_waitcnt lgkmcnt(3)
  v_mfma_f32_16x16x32_bf16 v[32:35], v[228:231], v[192:195], 0
  ds_read_b128 v[224:227], v244 offset:20480
  v_mfma_f32_16x16x32_bf16 v[36:39], v[228:231], v[196:199], 0
  s_waitcnt lgkmcnt(3)
  v_mfma_f32_16x16x32_bf16 v[32:35], v[232:235], v[200:203], v[32:35]
  ds_read_b128 v[228:231], v120 offset:20480
  v_mfma_f32_16x16x32_bf16 v[36:39], v[232:235], v[204:207], v[36:39]
  s_waitcnt lgkmcnt(3)
  v_mfma_f32_16x16x32_bf16 v[32:35], v[236:239], v[208:211], v[32:35]
  ds_read_b128 v[232:235], v121 offset:20480
  v_mfma_f32_16x16x32_bf16 v[36:39], v[236:239], v[212:215], v[36:39]
  s_waitcnt lgkmcnt(3)
  v_mfma_f32_16x16x32_bf16 v[32:35], v[240:243], v[216:219], v[32:35]
  ds_read_b128 v[236:239], v122 offset:20480
  v_mfma_f32_16x16x32_bf16 v[36:39], v[240:243], v[220:223], v[36:39]
  s_waitcnt lgkmcnt(3)
  v_mfma_f32_16x16x32_bf16 v[40:43], v[224:227], v[192:195], 0
  ds_read_b128 v[240:243], v244 offset:24576
  v_mfma_f32_16x16x32_bf16 v[44:47], v[224:227], v[196:199], 0
  s_waitcnt lgkmcnt(3)
  v_mfma_f32_16x16x32_bf16 v[40:43], v[228:231], v[200:203], v[40:43]
  ds_read_b128 v[224:227], v120 offset:24576
  v_mfma_f32_16x16x32_bf16 v[44:47], v[228:231], v[204:207], v[44:47]
  s_waitcnt lgkmcnt(3)
  v_mfma_f32_16x16x32_bf16 v[40:43], v[232:235], v[208:211], v[40:43]
  ds_read_b128 v[228:231], v121 offset:24576
  v_mfma_f32_16x16x32_bf16 v[44:47], v[232:235], v[212:215], v[44:47]
  s_waitcnt lgkmcnt(3)
  v_mfma_f32_16x16x32_bf16 v[40:43], v[236:239], v[216:219], v[40:43]
  ds_read_b128 v[232:235], v122 offset:24576
  v_mfma_f32_16x16x32_bf16 v[44:47], v[236:239], v[220:223], v[44:47]
  s_waitcnt lgkmcnt(3)
  v_mfma_f32_16x16x32_bf16 v[48:51], v[240:243], v[192:195], 0
  ds_read_b128 v[236:239], v244 offset:28672
  v_mfma_f32_16x16x32_bf16 v[52:55], v[240:243], v[196:199], 0
  s_waitcnt lgkmcnt(3)
  v_mfma_f32_16x16x32_bf16 v[48:51], v[224:227], v[200:203], v[48:51]
  ds_read_b128 v[240:243], v120 offset:28672
  v_mfma_f32_16x16x32_bf16 v[52:55], v[224:227], v[204:207], v[52:55]
  s_waitcnt lgkmcnt(3)
  v_mfma_f32_16x16x32_bf16 v[48:51], v[228:231], v[208:211], v[48:51]
  ds_read_b128 v[224:227], v121 offset:28672
  v_mfma_f32_16x16x32_bf16 v[52:55], v[228:231], v[212:215], v[52:55]
  s_waitcnt lgkmcnt(3)
  v_mfma_f32_16x16x32_bf16 v[48:51], v[232:235], v[216:219], v[48:51]
  ds_read_b128 v[228:231], v122 offset:28672
  v_mfma_f32_16x16x32_bf16 v[52:55], v[232:235], v[220:223], v[52:55]
  s_waitcnt lgkmcnt(3)
  v_mfma_f32_16x16x32_bf16 v[56:59], v[236:239], v[192:195], 0
  ds_read_b128 v[232:235], v244 offset:32768
  v_mfma_f32_16x16x32_bf16 v[60:63], v[236:239], v[196:199], 0
  s_waitcnt lgkmcnt(3)
  v_mfma_f32_16x16x32_bf16 v[56:59], v[240:243], v[200:203], v[56:59]
  ds_read_b128 v[236:239], v120 offset:32768
  v_mfma_f32_16x16x32_bf16 v[60:63], v[240:243], v[204:207], v[60:63]
  s_waitcnt lgkmcnt(3)
  v_mfma_f32_16x16x32_bf16 v[56:59], v[224:227], v[208:211], v[56:59]
  ds_read_b128 v[240:243], v121 offset:32768
  v_mfma_f32_16x16x32_bf16 v[60:63], v[224:227], v[212:215], v[60:63]
  s_waitcnt lgkmcnt(3)
  v_mfma_f32_16x16x32_bf16 v[56:59], v[228:231], v[216:219], v[56:59]
  ds_read_b128 v[224:227], v122 offset:32768
  v_mfma_f32_16x16x32_bf16 v[60:63], v[228:231], v[220:223], v[60:63]
  s_waitcnt lgkmcnt(3)
  v_mfma_f32_16x16x32_bf16 v[64:67], v[232:235], v[192:195], 0
  ds_read_b128 v[228:231], v244 offset:36864
  v_mfma_f32_16x16x32_bf16 v[68:71], v[232:235], v[196:199], 0
  s_waitcnt lgkmcnt(3)
  v_mfma_f32_16x16x32_bf16 v[64:67], v[236:239], v[200:203], v[64:67]
  ds_read_b128 v[232:235], v120 offset:36864
  v_mfma_f32_16x16x32_bf16 v[68:71], v[236:239], v[204:207], v[68:71]
  s_waitcnt lgkmcnt(3)
  v_mfma_f32_16x16x32_bf16 v[64:67], v[240:243], v[208:211], v[64:67]
  ds_read_b128 v[236:239], v121 offset:36864
  v_mfma_f32_16x16x32_bf16 v[68:71], v[240:243], v[212:215], v[68:71]
  s_waitcnt lgkmcnt(3)
  v_mfma_f32_16x16x32_bf16 v[64:67], v[224:227], v[216:219], v[64:67]
  ds_read_b128 v[240:243], v122 offset:36864
  v_mfma_f32_16x16x32_bf16 v[68:71], v[224:227], v[220:223], v[68:71]
  s_waitcnt lgkmcnt(3)
  v_mfma_f32_16x16x32_bf16 v[72:75], v[228:231], v[192:195], 0
  ds_read_b128 v[224:227], v244 offset:40960
  v_mfma_f32_16x16x32_bf16 v[76:79], v[228:231], v[196:199], 0
  s_waitcnt lgkmcnt(3)
  v_mfma_f32_16x16x32_bf16 v[72:75], v[232:235], v[200:203], v[72:75]
  ds_read_b128 v[228:231], v120 offset:40960
  v_mfma_f32_16x16x32_bf16 v[76:79], v[232:235], v[204:207], v[76:79]
  s_waitcnt lgkmcnt(3)
  v_mfma_f32_16x16x32_bf16 v[72:75], v[236:239], v[208:211], v[72:75]
  ds_read_b128 v[232:235], v121 offset:40960
  v_mfma_f32_16x16x32_bf16 v[76:79], v[236:239], v[212:215], v[76:79]
  s_waitcnt lgkmcnt(3)
  v_mfma_f32_16x16x32_bf16 v[72:75], v[240:243], v[216:219], v[72:75]
  ds_read_b128 v[236:239], v122 offset:40960
  v_mfma_f32_16x16x32_bf16 v[76:79], v[240:243], v[220:223], v[76:79]
  s_waitcnt lgkmcnt(3)
  v_mfma_f32_16x16x32_bf16 v[80:83], v[224:227], v[192:195], 0
  ds_read_b128 v[240:243], v244 offset:45056
  v_mfma_f32_16x16x32_bf16 v[84:87], v[224:227], v[196:199], 0
  s_waitcnt lgkmcnt(3)
  v_mfma_f32_16x16x32_bf16 v[80:83], v[228:231], v[200:203], v[80:83]
  ds_read_b128 v[224:227], v120 offset:45056
  v_mfma_f32_16x16x32_bf16 v[84:87], v[228:231], v[204:207], v[84:87]
  s_waitcnt lgkmcnt(3)
  v_mfma_f32_16x16x32_bf16 v[80:83], v[232:235], v[208:211], v[80:83]
  ds_read_b128 v[228:231], v121 offset:45056
  v_mfma_f32_16x16x32_bf16 v[84:87], v[232:235], v[212:215], v[84:87]
  s_waitcnt lgkmcnt(3)
  v_mfma_f32_16x16x32_bf16 v[80:83], v[236:239], v[216:219], v[80:83]
  ds_read_b128 v[232:235], v122 offset:45056
  v_mfma_f32_16x16x32_bf16 v[84:87], v[236:239], v[220:223], v[84:87]
  s_waitcnt lgkmcnt(3)
  v_mfma_f32_16x16x32_bf16 v[88:91], v[240:243], v[192:195], 0
  ds_read_b128 v[236:239], v244 offset:49152
  v_mfma_f32_16x16x32_bf16 v[92:95], v[240:243], v[196:199], 0
  s_waitcnt lgkmcnt(3)
  v_mfma_f32_16x16x32_bf16 v[88:91], v[224:227], v[200:203], v[88:91]
  ds_read_b128 v[240:243], v120 offset:49152
  v_mfma_f32_16x16x32_bf16 v[92:95], v[224:227], v[204:207], v[92:95]
  s_waitcnt lgkmcnt(3)
  v_mfma_f32_16x16x32_bf16 v[88:91], v[228:231], v[208:211], v[88:91]
  ds_read_b128 v[224:227], v121 offset:49152
  v_mfma_f32_16x16x32_bf16 v[92:95], v[228:231], v[212:215], v[92:95]
  s_waitcnt lgkmcnt(3)
  v_mfma_f32_16x16x32_bf16 v[88:91], v[232:235], v[216:219], v[88:91]
  ds_read_b128 v[228:231], v122 offset:49152
  v_mfma_f32_16x16x32_bf16 v[92:95], v[232:235], v[220:223], v[92:95]
  s_waitcnt lgkmcnt(3)
  v_mfma_f32_16x16x32_bf16 v[96:99], v[236:239], v[192:195], 0
  ds_read_b128 v[232:235], v244 offset:53248
  v_mfma_f32_16x16x32_bf16 v[100:103], v[236:239], v[196:199], 0
  s_waitcnt lgkmcnt(3)
  v_mfma_f32_16x16x32_bf16 v[96:99], v[240:243], v[200:203], v[96:99]
  ds_read_b128 v[236:239], v120 offset:53248
  v_mfma_f32_16x16x32_bf16 v[100:103], v[240:243], v[204:207], v[100:103]
  s_waitcnt lgkmcnt(3)
  v_mfma_f32_16x16x32_bf16 v[96:99], v[224:227], v[208:211], v[96:99]
  ds_read_b128 v[240:243], v121 offset:53248
  v_mfma_f32_16x16x32_bf16 v[100:103], v[224:227], v[212:215], v[100:103]
  s_waitcnt lgkmcnt(3)
  v_mfma_f32_16x16x32_bf16 v[96:99], v[228:231], v[216:219], v[96:99]
  ds_read_b128 v[224:227], v122 offset:53248
  v_mfma_f32_16x16x32_bf16 v[100:103], v[228:231], v[220:223], v[100:103]
  s_waitcnt lgkmcnt(3)
  v_mfma_f32_16x16x32_bf16 v[104:107], v[232:235], v[192:195], 0
  ds_read_b128 v[228:231], v244 offset:57344
  v_mfma_f32_16x16x32_bf16 v[108:111], v[232:235], v[196:199], 0
  s_waitcnt lgkmcnt(3)
  v_mfma_f32_16x16x32_bf16 v[104:107], v[236:239], v[200:203], v[104:107]
  ds_read_b128 v[232:235], v120 offset:57344
  v_mfma_f32_16x16x32_bf16 v[108:111], v[236:239], v[204:207], v[108:111]
  s_waitcnt lgkmcnt(3)
  v_mfma_f32_16x16x32_bf16 v[104:107], v[240:243], v[208:211], v[104:107]
  ds_read_b128 v[236:239], v121 offset:57344
  v_mfma_f32_16x16x32_bf16 v[108:111], v[240:243], v[212:215], v[108:111]
  s_waitcnt lgkmcnt(3)
  v_mfma_f32_16x16x32_bf16 v[104:107], v[224:227], v[216:219], v[104:107]
  ds_read_b128 v[240:243], v122 offset:57344
  v_mfma_f32_16x16x32_bf16 v[108:111], v[224:227], v[220:223], v[108:111]
  s_waitcnt lgkmcnt(3)
  v_mfma_f32_16x16x32_bf16 v[112:115], v[228:231], v[192:195], 0
  ds_read_b128 v[224:227], v244 offset:61440
  v_mfma_f32_16x16x32_bf16 v[116:119], v[228:231], v[196:199], 0
  s_waitcnt lgkmcnt(3)
  v_mfma_f32_16x16x32_bf16 v[112:115], v[232:235], v[200:203], v[112:115]
  ds_read_b128 v[228:231], v120 offset:61440
  v_mfma_f32_16x16x32_bf16 v[116:119], v[232:235], v[204:207], v[116:119]
  s_waitcnt lgkmcnt(3)
  v_mfma_f32_16x16x32_bf16 v[112:115], v[236:239], v[208:211], v[112:115]
  ds_read_b128 v[232:235], v121 offset:61440
  v_mfma_f32_16x16x32_bf16 v[116:119], v[236:239], v[212:215], v[116:119]
  s_waitcnt lgkmcnt(3)
  v_mfma_f32_16x16x32_bf16 v[112:115], v[240:243], v[216:219], v[112:115]
  ds_read_b128 v[236:239], v122 offset:61440
  v_mfma_f32_16x16x32_bf16 v[116:119], v[240:243], v[220:223], v[116:119]
  s_waitcnt lgkmcnt(3)
  v_mfma_f32_16x16x32_bf16 v[120:123], v[224:227], v[192:195], 0
  v_mfma_f32_16x16x32_bf16 v[124:127], v[224:227], v[196:199], 0
  s_waitcnt lgkmcnt(2)
  v_mfma_f32_16x16x32_bf16 v[120:123], v[228:231], v[200:203], v[120:123]
  v_mfma_f32_16x16x32_bf16 v[124:127], v[228:231], v[204:207], v[124:127]
  s_waitcnt lgkmcnt(1)
  v_mfma_f32_16x16x32_bf16 v[120:123], v[232:235], v[208:211], v[120:123]
  v_mfma_f32_16x16x32_bf16 v[124:127], v[232:235], v[212:215], v[124:127]
  s_waitcnt lgkmcnt(0)
  v_mfma_f32_16x16x32_bf16 v[120:123], v[236:239], v[216:219], v[120:123]
  v_mfma_f32_16x16x32_bf16 v[124:127], v[236:239], v[220:223], v[124:127]
  v_max3_f32 v224, v0, v1, v2
  v_max3_f32 v225, v4, v5, v6
  v_max3_f32 v224, v3, v8, v224
  v_max3_f32 v225, v7, v12, v225
  v_max3_f32 v224, v9, v10, v224
  v_max3_f32 v225, v13, v14, v225
  v_max3_f32 v224, v11, v16, v224
  v_max3_f32 v225, v15, v20, v225
  v_max3_f32 v224, v17, v18, v224
  v_max3_f32 v225, v21, v22, v225
  v_max3_f32 v224, v19, v24, v224
  v_max3_f32 v225, v23, v28, v225
  v_max3_f32 v224, v25, v26, v224
  v_max3_f32 v225, v29, v30, v225
  v_max3_f32 v224, v27, v32, v224
  v_max3_f32 v225, v31, v36, v225
  v_max3_f32 v224, v33, v34, v224
  v_max3_f32 v225, v37, v38, v225
  v_max3_f32 v224, v35, v40, v224
  v_max3_f32 v225, v39, v44, v225
  v_max3_f32 v224, v41, v42, v224
  v_max3_f32 v225, v45, v46, v225
  v_max3_f32 v224, v43, v48, v224
  v_max3_f32 v225, v47, v52, v225
  v_max3_f32 v224, v49, v50, v224
  v_max3_f32 v225, v53, v54, v225
  v_max3_f32 v224, v51, v56, v224
  v_max3_f32 v225, v55, v60, v225
  v_max3_f32 v224, v57, v58, v224
  v_max3_f32 v225, v61, v62, v225
  v_max3_f32 v224, v59, v64, v224
  v_max3_f32 v225, v63, v68, v225
  v_max3_f32 v224, v65, v66, v224
  v_max3_f32 v225, v69, v70, v225
  v_max3_f32 v224, v67, v72, v224
  v_max3_f32 v225, v71, v76, v225
  v_max3_f32 v224, v73, v74, v224
  v_max3_f32 v225, v77, v78, v225
  v_max3_f32 v224, v75, v80, v224
  v_max3_f32 v225, v79, v84, v225
  v_max3_f32 v224, v81, v82, v224
  v_max3_f32 v225, v85, v86, v225
  v_max3_f32 v224, v83, v88, v224
  v_max3_f32 v225, v87, v92, v225
  v_max3_f32 v224, v89, v90, v224
  v_max3_f32 v225, v93, v94, v225
  v_max3_f32 v224, v91, v96, v224
  v_max3_f32 v225, v95, v100, v225
  v_max3_f32 v224, v97, v98, v224
  v_max3_f32 v225, v101, v102, v225
  v_max3_f32 v224, v99, v104, v224
  v_max3_f32 v225, v103, v108, v225
  v_max3_f32 v224, v105, v106, v224
  v_max3_f32 v225, v109, v110, v225
  v_max3_f32 v224, v107, v112, v224
  v_max3_f32 v225, v111, v116, v225
  v_max3_f32 v224, v113, v114, v224
  v_max3_f32 v225, v117, v118, v225
  v_max3_f32 v224, v115, v120, v224
  v_max3_f32 v225, v119, v124, v225
  v_max3_f32 v224, v121, v122, v224
  v_max3_f32 v225, v125, v126, v225
  v_max_f32 v224, v123, v224
  v_max_f32 v225, v127, v225
  s_nop 1
  v_permlane32_swap_b32 v224, v225
  v_max_f32 v224, v224, v225
  v_mov_b32 v225, v224
  s_nop 1
  v_permlane16_swap_b32 v224, v225
  v_max_f32 v224, v224, v225
  v_mov_b32 v225, v224
  s_nop 1
  v_permlane32_swap_b32 v224, v225
  v_sub_f32 v0, v0, v224
  v_sub_f32 v4, v4, v225
  v_sub_f32 v1, v1, v224
  v_sub_f32 v5, v5, v225
  v_sub_f32 v2, v2, v224
  v_sub_f32 v6, v6, v225
  v_sub_f32 v3, v3, v224
  v_sub_f32 v7, v7, v225
  v_sub_f32 v8, v8, v224
  v_sub_f32 v12, v12, v225
  v_sub_f32 v9, v9, v224
  v_sub_f32 v13, v13, v225
  v_sub_f32 v10, v10, v224
  v_sub_f32 v14, v14, v225
  v_sub_f32 v11, v11, v224
  v_sub_f32 v15, v15, v225
  v_exp_f32 v0, v0
  v_exp_f32 v4, v4
  v_exp_f32 v1, v1
  v_exp_f32 v5, v5
  v_exp_f32 v2, v2
  v_exp_f32 v6, v6
  v_exp_f32 v3, v3
  v_exp_f32 v7, v7
  v_exp_f32 v8, v8
  v_exp_f32 v12, v12
  v_exp_f32 v9, v9
  v_exp_f32 v13, v13
  v_exp_f32 v10, v10
  v_exp_f32 v14, v14
  v_exp_f32 v11, v11
  v_exp_f32 v15, v15
  v_cvt_pk_bf16_f32 v0, v0, v1
  v_cvt_pk_bf16_f32 v1, v2, v3
  v_cvt_pk_bf16_f32 v2, v8, v9
  v_cvt_pk_bf16_f32 v3, v10, v11
  v_cvt_pk_bf16_f32 v4, v4, v5
  v_cvt_pk_bf16_f32 v5, v6, v7
  v_cvt_pk_bf16_f32 v6, v12, v13
  v_cvt_pk_bf16_f32 v7, v14, v15
  v_sub_f32 v16, v16, v224
  v_sub_f32 v20, v20, v225
  v_sub_f32 v17, v17, v224
  v_sub_f32 v21, v21, v225
  v_sub_f32 v18, v18, v224
  v_sub_f32 v22, v22, v225
  v_sub_f32 v19, v19, v224
  v_sub_f32 v23, v23, v225
  v_sub_f32 v24, v24, v224
  v_sub_f32 v28, v28, v225
  v_sub_f32 v25, v25, v224
  v_sub_f32 v29, v29, v225
  v_sub_f32 v26, v26, v224
  v_sub_f32 v30, v30, v225
  v_sub_f32 v27, v27, v224
  v_sub_f32 v31, v31, v225
  v_exp_f32 v16, v16
  v_exp_f32 v20, v20
  v_exp_f32 v17, v17
  v_exp_f32 v21, v21
  v_exp_f32 v18, v18
  v_exp_f32 v22, v22
  v_exp_f32 v19, v19
  v_exp_f32 v23, v23
  v_exp_f32 v24, v24
  v_exp_f32 v28, v28
  v_exp_f32 v25, v25
  v_exp_f32 v29, v29
  v_exp_f32 v26, v26
  v_exp_f32 v30, v30
  v_exp_f32 v27, v27
  v_exp_f32 v31, v31
  v_cvt_pk_bf16_f32 v8, v16, v17
  v_cvt_pk_bf16_f32 v9, v18, v19
  v_cvt_pk_bf16_f32 v10, v24, v25
  v_cvt_pk_bf16_f32 v11, v26, v27
  v_cvt_pk_bf16_f32 v12, v20, v21
  v_cvt_pk_bf16_f32 v13, v22, v23
  v_cvt_pk_bf16_f32 v14, v28, v29
  v_cvt_pk_bf16_f32 v15, v30, v31
  v_sub_f32 v32, v32, v224
  v_sub_f32 v36, v36, v225
  v_sub_f32 v33, v33, v224
  v_sub_f32 v37, v37, v225
  v_sub_f32 v34, v34, v224
  v_sub_f32 v38, v38, v225
  v_sub_f32 v35, v35, v224
  v_sub_f32 v39, v39, v225
  v_sub_f32 v40, v40, v224
  v_sub_f32 v44, v44, v225
  v_sub_f32 v41, v41, v224
  v_sub_f32 v45, v45, v225
  v_sub_f32 v42, v42, v224
  v_sub_f32 v46, v46, v225
  v_sub_f32 v43, v43, v224
  v_sub_f32 v47, v47, v225
  v_exp_f32 v32, v32
  v_exp_f32 v36, v36
  v_exp_f32 v33, v33
  v_exp_f32 v37, v37
  v_exp_f32 v34, v34
  v_exp_f32 v38, v38
  v_exp_f32 v35, v35
  v_exp_f32 v39, v39
  v_exp_f32 v40, v40
  v_exp_f32 v44, v44
  v_exp_f32 v41, v41
  v_exp_f32 v45, v45
  v_exp_f32 v42, v42
  v_exp_f32 v46, v46
  v_exp_f32 v43, v43
  v_exp_f32 v47, v47
  v_cvt_pk_bf16_f32 v16, v32, v33
  v_cvt_pk_bf16_f32 v17, v34, v35
  v_cvt_pk_bf16_f32 v18, v40, v41
  v_cvt_pk_bf16_f32 v19, v42, v43
  v_cvt_pk_bf16_f32 v20, v36, v37
  v_cvt_pk_bf16_f32 v21, v38, v39
  v_cvt_pk_bf16_f32 v22, v44, v45
  v_cvt_pk_bf16_f32 v23, v46, v47
  v_sub_f32 v48, v48, v224
  v_sub_f32 v52, v52, v225
  v_sub_f32 v49, v49, v224
  v_sub_f32 v53, v53, v225
  v_sub_f32 v50, v50, v224
  v_sub_f32 v54, v54, v225
  v_sub_f32 v51, v51, v224
  v_sub_f32 v55, v55, v225
  v_sub_f32 v56, v56, v224
  v_sub_f32 v60, v60, v225
  v_sub_f32 v57, v57, v224
  v_sub_f32 v61, v61, v225
  v_sub_f32 v58, v58, v224
  v_sub_f32 v62, v62, v225
  v_sub_f32 v59, v59, v224
  v_sub_f32 v63, v63, v225
  v_exp_f32 v48, v48
  v_exp_f32 v52, v52
  v_exp_f32 v49, v49
  v_exp_f32 v53, v53
  v_exp_f32 v50, v50
  v_exp_f32 v54, v54
  v_exp_f32 v51, v51
  v_exp_f32 v55, v55
  v_exp_f32 v56, v56
  v_exp_f32 v60, v60
  v_exp_f32 v57, v57
  v_exp_f32 v61, v61
  v_exp_f32 v58, v58
  v_exp_f32 v62, v62
  v_exp_f32 v59, v59
  v_exp_f32 v63, v63
  v_cvt_pk_bf16_f32 v24, v48, v49
  v_cvt_pk_bf16_f32 v25, v50, v51
  v_cvt_pk_bf16_f32 v26, v56, v57
  v_cvt_pk_bf16_f32 v27, v58, v59
  v_cvt_pk_bf16_f32 v28, v52, v53
  v_cvt_pk_bf16_f32 v29, v54, v55
  v_cvt_pk_bf16_f32 v30, v60, v61
  v_cvt_pk_bf16_f32 v31, v62, v63
  v_sub_f32 v64, v64, v224
  v_sub_f32 v68, v68, v225
  v_sub_f32 v65, v65, v224
  v_sub_f32 v69, v69, v225
  v_sub_f32 v66, v66, v224
  v_sub_f32 v70, v70, v225
  v_sub_f32 v67, v67, v224
  v_sub_f32 v71, v71, v225
  v_sub_f32 v72, v72, v224
  v_sub_f32 v76, v76, v225
  v_sub_f32 v73, v73, v224
  v_sub_f32 v77, v77, v225
  v_sub_f32 v74, v74, v224
  v_sub_f32 v78, v78, v225
  v_sub_f32 v75, v75, v224
  v_sub_f32 v79, v79, v225
  v_exp_f32 v64, v64
  v_exp_f32 v68, v68
  v_exp_f32 v65, v65
  v_exp_f32 v69, v69
  v_exp_f32 v66, v66
  v_exp_f32 v70, v70
  v_exp_f32 v67, v67
  v_exp_f32 v71, v71
  v_exp_f32 v72, v72
  v_exp_f32 v76, v76
  v_exp_f32 v73, v73
  v_exp_f32 v77, v77
  v_exp_f32 v74, v74
  v_exp_f32 v78, v78
  v_exp_f32 v75, v75
  v_exp_f32 v79, v79
  v_cvt_pk_bf16_f32 v32, v64, v65
  v_cvt_pk_bf16_f32 v33, v66, v67
  v_cvt_pk_bf16_f32 v34, v72, v73
  v_cvt_pk_bf16_f32 v35, v74, v75
  v_cvt_pk_bf16_f32 v36, v68, v69
  v_cvt_pk_bf16_f32 v37, v70, v71
  v_cvt_pk_bf16_f32 v38, v76, v77
  v_cvt_pk_bf16_f32 v39, v78, v79
  v_sub_f32 v80, v80, v224
  v_sub_f32 v84, v84, v225
  v_sub_f32 v81, v81, v224
  v_sub_f32 v85, v85, v225
  v_sub_f32 v82, v82, v224
  v_sub_f32 v86, v86, v225
  v_sub_f32 v83, v83, v224
  v_sub_f32 v87, v87, v225
  v_sub_f32 v88, v88, v224
  v_sub_f32 v92, v92, v225
  v_sub_f32 v89, v89, v224
  v_sub_f32 v93, v93, v225
  v_sub_f32 v90, v90, v224
  v_sub_f32 v94, v94, v225
  v_sub_f32 v91, v91, v224
  v_sub_f32 v95, v95, v225
  v_exp_f32 v80, v80
  v_exp_f32 v84, v84
  v_exp_f32 v81, v81
  v_exp_f32 v85, v85
  v_exp_f32 v82, v82
  v_exp_f32 v86, v86
  v_exp_f32 v83, v83
  v_exp_f32 v87, v87
  v_exp_f32 v88, v88
  v_exp_f32 v92, v92
  v_exp_f32 v89, v89
  v_exp_f32 v93, v93
  v_exp_f32 v90, v90
  v_exp_f32 v94, v94
  v_exp_f32 v91, v91
  v_exp_f32 v95, v95
  v_cvt_pk_bf16_f32 v40, v80, v81
  v_cvt_pk_bf16_f32 v41, v82, v83
  v_cvt_pk_bf16_f32 v42, v88, v89
  v_cvt_pk_bf16_f32 v43, v90, v91
  v_cvt_pk_bf16_f32 v44, v84, v85
  v_cvt_pk_bf16_f32 v45, v86, v87
  v_cvt_pk_bf16_f32 v46, v92, v93
  v_cvt_pk_bf16_f32 v47, v94, v95
  v_sub_f32 v96, v96, v224
  v_sub_f32 v100, v100, v225
  v_sub_f32 v97, v97, v224
  v_sub_f32 v101, v101, v225
  v_sub_f32 v98, v98, v224
  v_sub_f32 v102, v102, v225
  v_sub_f32 v99, v99, v224
  v_sub_f32 v103, v103, v225
  v_sub_f32 v104, v104, v224
  v_sub_f32 v108, v108, v225
  v_sub_f32 v105, v105, v224
  v_sub_f32 v109, v109, v225
  v_sub_f32 v106, v106, v224
  v_sub_f32 v110, v110, v225
  v_sub_f32 v107, v107, v224
  v_sub_f32 v111, v111, v225
  v_exp_f32 v96, v96
  v_exp_f32 v100, v100
  v_exp_f32 v97, v97
  v_exp_f32 v101, v101
  v_exp_f32 v98, v98
  v_exp_f32 v102, v102
  v_exp_f32 v99, v99
  v_exp_f32 v103, v103
  v_exp_f32 v104, v104
  v_exp_f32 v108, v108
  v_exp_f32 v105, v105
  v_exp_f32 v109, v109
  v_exp_f32 v106, v106
  v_exp_f32 v110, v110
  v_exp_f32 v107, v107
  v_exp_f32 v111, v111
  v_cvt_pk_bf16_f32 v48, v96, v97
  v_cvt_pk_bf16_f32 v49, v98, v99
  v_cvt_pk_bf16_f32 v50, v104, v105
  v_cvt_pk_bf16_f32 v51, v106, v107
  v_cvt_pk_bf16_f32 v52, v100, v101
  v_cvt_pk_bf16_f32 v53, v102, v103
  v_cvt_pk_bf16_f32 v54, v108, v109
  v_cvt_pk_bf16_f32 v55, v110, v111
  v_sub_f32 v112, v112, v224
  v_sub_f32 v116, v116, v225
  v_sub_f32 v113, v113, v224
  v_sub_f32 v117, v117, v225
  v_sub_f32 v114, v114, v224
  v_sub_f32 v118, v118, v225
  v_sub_f32 v115, v115, v224
  v_sub_f32 v119, v119, v225
  v_sub_f32 v120, v120, v224
  v_sub_f32 v124, v124, v225
  v_sub_f32 v121, v121, v224
  v_sub_f32 v125, v125, v225
  v_sub_f32 v122, v122, v224
  v_sub_f32 v126, v126, v225
  v_sub_f32 v123, v123, v224
  v_sub_f32 v127, v127, v225
  v_exp_f32 v112, v112
  v_exp_f32 v116, v116
  v_exp_f32 v113, v113
  v_exp_f32 v117, v117
  v_exp_f32 v114, v114
  v_exp_f32 v118, v118
  v_exp_f32 v115, v115
  v_exp_f32 v119, v119
  v_exp_f32 v120, v120
  v_exp_f32 v124, v124
  v_exp_f32 v121, v121
  v_exp_f32 v125, v125
  v_exp_f32 v122, v122
  v_exp_f32 v126, v126
  v_exp_f32 v123, v123
  v_exp_f32 v127, v127
  v_cvt_pk_bf16_f32 v56, v112, v113
  v_cvt_pk_bf16_f32 v57, v114, v115
  v_cvt_pk_bf16_f32 v58, v120, v121
  v_cvt_pk_bf16_f32 v59, v122, v123
  v_cvt_pk_bf16_f32 v60, v116, v117
  v_cvt_pk_bf16_f32 v61, v118, v119
  v_cvt_pk_bf16_f32 v62, v124, v125
  v_cvt_pk_bf16_f32 v63, v126, v127
  v_xor_b32 v96, 0x10000, v247
  v_xor_b32 v97, 0x10110, v247
  v_xor_b32 v98, 0x10220, v247
  v_xor_b32 v99, 0x10330, v247
  v_xor_b32 v100, 0x11040, v247
  v_xor_b32 v101, 0x11150, v247
  v_xor_b32 v102, 0x11260, v247
  v_xor_b32 v103, 0x11370, v247
  v_lshrrev_b32 v108, 6, v247
  v_bfe_i32 v107, v247, 4, 1
  v_xor_b32 v108, v108, v247
  v_and_b32 v107, 0xaaaaaaaa, v107
  v_bfe_i32 v108, v108, 5, 1
  v_xor_b32 v107, 0x44444444, v107
  v_and_b32 v108, 0x3f803f80, v108
  v_mov_b32 v109, v108
  v_mov_b32 v110, v108
  v_mov_b32 v111, v108
  v_mov_b32 v248, 0
  v_mov_b32 v249, 0
  v_mov_b32 v250, 0
  v_mov_b32 v251, 0
  ds_read_b128 v[64:67], v96 offset:0
  ds_read_b128 v[68:71], v96 offset:8192
  ds_read_b128 v[72:75], v96 offset:16384
  ds_read_b128 v[76:79], v96 offset:24576
  ds_read_b128 v[80:83], v96 offset:32768
  ds_read_b128 v[84:87], v96 offset:40960
  v_smfmac_f32_16x16x64_bf16 v[248:251], v[108:111], v[0:7], v107
  v_smfmac_f32_16x16x64_bf16 v[248:251], v[108:111], v[8:15], v107
  v_smfmac_f32_16x16x64_bf16 v[248:251], v[108:111], v[16:23], v107
  v_smfmac_f32_16x16x64_bf16 v[248:251], v[108:111], v[24:31], v107
  v_smfmac_f32_16x16x64_bf16 v[248:251], v[108:111], v[32:39], v107
  v_smfmac_f32_16x16x64_bf16 v[248:251], v[108:111], v[40:47], v107
  v_smfmac_f32_16x16x64_bf16 v[248:251], v[108:111], v[48:55], v107
  v_smfmac_f32_16x16x64_bf16 v[248:251], v[108:111], v[56:63], v107
  s_waitcnt lgkmcnt(5)
  v_mfma_f32_16x16x32_bf16 v[128:131], v[0:3], v[64:67], 0
  ds_read_b128 v[88:91], v96 offset:49152
  v_mfma_f32_16x16x32_bf16 v[132:135], v[4:7], v[64:67], 0
  s_waitcnt lgkmcnt(5)
  v_mfma_f32_16x16x32_bf16 v[128:131], v[8:11], v[68:71], v[128:131]
  ds_read_b128 v[92:95], v96 offset:57344
  v_mfma_f32_16x16x32_bf16 v[132:135], v[12:15], v[68:71], v[132:135]
  s_waitcnt lgkmcnt(5)
  v_mfma_f32_16x16x32_bf16 v[128:131], v[16:19], v[72:75], v[128:131]
  ds_read_b128 v[64:67], v97 offset:0
  v_mfma_f32_16x16x32_bf16 v[132:135], v[20:23], v[72:75], v[132:135]
  v_add_f32 v252, v250, v251
  s_waitcnt lgkmcnt(5)
  v_mfma_f32_16x16x32_bf16 v[128:131], v[24:27], v[76:79], v[128:131]
  ds_read_b128 v[68:71], v97 offset:8192
  v_mfma_f32_16x16x32_bf16 v[132:135], v[28:31], v[76:79], v[132:135]
  v_add_f32 v253, v248, v249
  s_waitcnt lgkmcnt(5)
  v_mfma_f32_16x16x32_bf16 v[128:131], v[32:35], v[80:83], v[128:131]
  ds_read_b128 v[72:75], v97 offset:16384
  v_mfma_f32_16x16x32_bf16 v[132:135], v[36:39], v[80:83], v[132:135]
  s_waitcnt lgkmcnt(5)
  v_mfma_f32_16x16x32_bf16 v[128:131], v[40:43], v[84:87], v[128:131]
  ds_read_b128 v[76:79], v97 offset:24576
  v_mfma_f32_16x16x32_bf16 v[132:135], v[44:47], v[84:87], v[132:135]
  s_waitcnt lgkmcnt(5)
  v_mfma_f32_16x16x32_bf16 v[128:131], v[48:51], v[88:91], v[128:131]
  ds_read_b128 v[80:83], v97 offset:32768
  v_mfma_f32_16x16x32_bf16 v[132:135], v[52:55], v[88:91], v[132:135]
  s_waitcnt lgkmcnt(5)
  v_mfma_f32_16x16x32_bf16 v[128:131], v[56:59], v[92:95], v[128:131]
  ds_read_b128 v[84:87], v97 offset:40960
  v_mfma_f32_16x16x32_bf16 v[132:135], v[60:63], v[92:95], v[132:135]
  s_waitcnt lgkmcnt(5)
  v_mfma_f32_16x16x32_bf16 v[136:139], v[0:3], v[64:67], 0
  ds_read_b128 v[88:91], v97 offset:49152
  v_mfma_f32_16x16x32_bf16 v[140:143], v[4:7], v[64:67], 0
  s_waitcnt lgkmcnt(5)
  v_mfma_f32_16x16x32_bf16 v[136:139], v[8:11], v[68:71], v[136:139]
  ds_read_b128 v[92:95], v97 offset:57344
  v_mfma_f32_16x16x32_bf16 v[140:143], v[12:15], v[68:71], v[140:143]
  s_waitcnt lgkmcnt(5)
  v_mfma_f32_16x16x32_bf16 v[136:139], v[16:19], v[72:75], v[136:139]
  ds_read_b128 v[64:67], v98 offset:0
  v_mfma_f32_16x16x32_bf16 v[140:143], v[20:23], v[72:75], v[140:143]
  s_waitcnt lgkmcnt(5)
  v_mfma_f32_16x16x32_bf16 v[136:139], v[24:27], v[76:79], v[136:139]
  ds_read_b128 v[68:71], v98 offset:8192
  v_mfma_f32_16x16x32_bf16 v[140:143], v[28:31], v[76:79], v[140:143]
  s_waitcnt lgkmcnt(5)
  v_mfma_f32_16x16x32_bf16 v[136:139], v[32:35], v[80:83], v[136:139]
  ds_read_b128 v[72:75], v98 offset:16384
  v_mfma_f32_16x16x32_bf16 v[140:143], v[36:39], v[80:83], v[140:143]
  s_waitcnt lgkmcnt(5)
  v_mfma_f32_16x16x32_bf16 v[136:139], v[40:43], v[84:87], v[136:139]
  ds_read_b128 v[76:79], v98 offset:24576
  v_mfma_f32_16x16x32_bf16 v[140:143], v[44:47], v[84:87], v[140:143]
  s_waitcnt lgkmcnt(5)
  v_mfma_f32_16x16x32_bf16 v[136:139], v[48:51], v[88:91], v[136:139]
  ds_read_b128 v[80:83], v98 offset:32768
  v_mfma_f32_16x16x32_bf16 v[140:143], v[52:55], v[88:91], v[140:143]
  s_waitcnt lgkmcnt(5)
  v_mfma_f32_16x16x32_bf16 v[136:139], v[56:59], v[92:95], v[136:139]
  ds_read_b128 v[84:87], v98 offset:40960
  v_mfma_f32_16x16x32_bf16 v[140:143], v[60:63], v[92:95], v[140:143]
  s_waitcnt lgkmcnt(5)
  v_mfma_f32_16x16x32_bf16 v[144:147], v[0:3], v[64:67], 0
  ds_read_b128 v[88:91], v98 offset:49152
  v_mfma_f32_16x16x32_bf16 v[148:151], v[4:7], v[64:67], 0
  s_waitcnt lgkmcnt(5)
  v_mfma_f32_16x16x32_bf16 v[144:147], v[8:11], v[68:71], v[144:147]
  ds_read_b128 v[92:95], v98 offset:57344
  v_mfma_f32_16x16x32_bf16 v[148:151], v[12:15], v[68:71], v[148:151]
  s_waitcnt lgkmcnt(5)
  v_mfma_f32_16x16x32_bf16 v[144:147], v[16:19], v[72:75], v[144:147]
  ds_read_b128 v[64:67], v99 offset:0
  v_mfma_f32_16x16x32_bf16 v[148:151], v[20:23], v[72:75], v[148:151]
  s_waitcnt lgkmcnt(5)
  v_mfma_f32_16x16x32_bf16 v[144:147], v[24:27], v[76:79], v[144:147]
  ds_read_b128 v[68:71], v99 offset:8192
  v_mfma_f32_16x16x32_bf16 v[148:151], v[28:31], v[76:79], v[148:151]
  s_waitcnt lgkmcnt(5)
  v_mfma_f32_16x16x32_bf16 v[144:147], v[32:35], v[80:83], v[144:147]
  ds_read_b128 v[72:75], v99 offset:16384
  v_mfma_f32_16x16x32_bf16 v[148:151], v[36:39], v[80:83], v[148:151]
  s_waitcnt lgkmcnt(5)
  v_mfma_f32_16x16x32_bf16 v[144:147], v[40:43], v[84:87], v[144:147]
  ds_read_b128 v[76:79], v99 offset:24576
  v_mfma_f32_16x16x32_bf16 v[148:151], v[44:47], v[84:87], v[148:151]
  s_waitcnt lgkmcnt(5)
  v_mfma_f32_16x16x32_bf16 v[144:147], v[48:51], v[88:91], v[144:147]
  ds_read_b128 v[80:83], v99 offset:32768
  v_mfma_f32_16x16x32_bf16 v[148:151], v[52:55], v[88:91], v[148:151]
  s_waitcnt lgkmcnt(5)
  v_mfma_f32_16x16x32_bf16 v[144:147], v[56:59], v[92:95], v[144:147]
  ds_read_b128 v[84:87], v99 offset:40960
  v_mfma_f32_16x16x32_bf16 v[148:151], v[60:63], v[92:95], v[148:151]
  s_waitcnt lgkmcnt(5)
  v_mfma_f32_16x16x32_bf16 v[152:155], v[0:3], v[64:67], 0
  ds_read_b128 v[88:91], v99 offset:49152
  v_mfma_f32_16x16x32_bf16 v[156:159], v[4:7], v[64:67], 0
  s_waitcnt lgkmcnt(5)
  v_mfma_f32_16x16x32_bf16 v[152:155], v[8:11], v[68:71], v[152:155]
  ds_read_b128 v[92:95], v99 offset:57344
  v_mfma_f32_16x16x32_bf16 v[156:159], v[12:15], v[68:71], v[156:159]
  s_waitcnt lgkmcnt(5)
  v_mfma_f32_16x16x32_bf16 v[152:155], v[16:19], v[72:75], v[152:155]
  ds_read_b128 v[64:67], v100 offset:0
  v_mfma_f32_16x16x32_bf16 v[156:159], v[20:23], v[72:75], v[156:159]
  s_waitcnt lgkmcnt(5)
  v_mfma_f32_16x16x32_bf16 v[152:155], v[24:27], v[76:79], v[152:155]
  ds_read_b128 v[68:71], v100 offset:8192
  v_mfma_f32_16x16x32_bf16 v[156:159], v[28:31], v[76:79], v[156:159]
  s_waitcnt lgkmcnt(5)
  v_mfma_f32_16x16x32_bf16 v[152:155], v[32:35], v[80:83], v[152:155]
  ds_read_b128 v[72:75], v100 offset:16384
  v_mfma_f32_16x16x32_bf16 v[156:159], v[36:39], v[80:83], v[156:159]
  s_waitcnt lgkmcnt(5)
  v_mfma_f32_16x16x32_bf16 v[152:155], v[40:43], v[84:87], v[152:155]
  ds_read_b128 v[76:79], v100 offset:24576
  v_mfma_f32_16x16x32_bf16 v[156:159], v[44:47], v[84:87], v[156:159]
  s_waitcnt lgkmcnt(5)
  v_mfma_f32_16x16x32_bf16 v[152:155], v[48:51], v[88:91], v[152:155]
  ds_read_b128 v[80:83], v100 offset:32768
  v_mfma_f32_16x16x32_bf16 v[156:159], v[52:55], v[88:91], v[156:159]
  s_waitcnt lgkmcnt(5)
  v_mfma_f32_16x16x32_bf16 v[152:155], v[56:59], v[92:95], v[152:155]
  ds_read_b128 v[84:87], v100 offset:40960
  v_mfma_f32_16x16x32_bf16 v[156:159], v[60:63], v[92:95], v[156:159]
  s_waitcnt lgkmcnt(5)
  v_mfma_f32_16x16x32_bf16 v[160:163], v[0:3], v[64:67], 0
  ds_read_b128 v[88:91], v100 offset:49152
  v_mfma_f32_16x16x32_bf16 v[164:167], v[4:7], v[64:67], 0
  s_waitcnt lgkmcnt(5)
  v_mfma_f32_16x16x32_bf16 v[160:163], v[8:11], v[68:71], v[160:163]
  ds_read_b128 v[92:95], v100 offset:57344
  v_mfma_f32_16x16x32_bf16 v[164:167], v[12:15], v[68:71], v[164:167]
  s_waitcnt lgkmcnt(5)
  v_mfma_f32_16x16x32_bf16 v[160:163], v[16:19], v[72:75], v[160:163]
  ds_read_b128 v[64:67], v101 offset:0
  v_mfma_f32_16x16x32_bf16 v[164:167], v[20:23], v[72:75], v[164:167]
  s_waitcnt lgkmcnt(5)
  v_mfma_f32_16x16x32_bf16 v[160:163], v[24:27], v[76:79], v[160:163]
  ds_read_b128 v[68:71], v101 offset:8192
  v_mfma_f32_16x16x32_bf16 v[164:167], v[28:31], v[76:79], v[164:167]
  s_waitcnt lgkmcnt(5)
  v_mfma_f32_16x16x32_bf16 v[160:163], v[32:35], v[80:83], v[160:163]
  ds_read_b128 v[72:75], v101 offset:16384
  v_mfma_f32_16x16x32_bf16 v[164:167], v[36:39], v[80:83], v[164:167]
  s_waitcnt lgkmcnt(5)
  v_mfma_f32_16x16x32_bf16 v[160:163], v[40:43], v[84:87], v[160:163]
  ds_read_b128 v[76:79], v101 offset:24576
  v_mfma_f32_16x16x32_bf16 v[164:167], v[44:47], v[84:87], v[164:167]
  s_waitcnt lgkmcnt(5)
  v_mfma_f32_16x16x32_bf16 v[160:163], v[48:51], v[88:91], v[160:163]
  ds_read_b128 v[80:83], v101 offset:32768
  v_mfma_f32_16x16x32_bf16 v[164:167], v[52:55], v[88:91], v[164:167]
  s_waitcnt lgkmcnt(5)
  v_mfma_f32_16x16x32_bf16 v[160:163], v[56:59], v[92:95], v[160:163]
  ds_read_b128 v[84:87], v101 offset:40960
  v_mfma_f32_16x16x32_bf16 v[164:167], v[60:63], v[92:95], v[164:167]
  s_waitcnt lgkmcnt(5)
  v_mfma_f32_16x16x32_bf16 v[168:171], v[0:3], v[64:67], 0
  ds_read_b128 v[88:91], v101 offset:49152
  v_mfma_f32_16x16x32_bf16 v[172:175], v[4:7], v[64:67], 0
  s_waitcnt lgkmcnt(5)
  v_mfma_f32_16x16x32_bf16 v[168:171], v[8:11], v[68:71], v[168:171]
  ds_read_b128 v[92:95], v101 offset:57344
  v_mfma_f32_16x16x32_bf16 v[172:175], v[12:15], v[68:71], v[172:175]
  s_waitcnt lgkmcnt(5)
  v_mfma_f32_16x16x32_bf16 v[168:171], v[16:19], v[72:75], v[168:171]
  ds_read_b128 v[64:67], v102 offset:0
  v_mfma_f32_16x16x32_bf16 v[172:175], v[20:23], v[72:75], v[172:175]
  s_waitcnt lgkmcnt(5)
  v_mfma_f32_16x16x32_bf16 v[168:171], v[24:27], v[76:79], v[168:171]
  ds_read_b128 v[68:71], v102 offset:8192
  v_mfma_f32_16x16x32_bf16 v[172:175], v[28:31], v[76:79], v[172:175]
  s_waitcnt lgkmcnt(5)
  v_mfma_f32_16x16x32_bf16 v[168:171], v[32:35], v[80:83], v[168:171]
  ds_read_b128 v[72:75], v102 offset:16384
  v_mfma_f32_16x16x32_bf16 v[172:175], v[36:39], v[80:83], v[172:175]
  s_waitcnt lgkmcnt(5)
  v_mfma_f32_16x16x32_bf16 v[168:171], v[40:43], v[84:87], v[168:171]
  ds_read_b128 v[76:79], v102 offset:24576
  v_mfma_f32_16x16x32_bf16 v[172:175], v[44:47], v[84:87], v[172:175]
  s_waitcnt lgkmcnt(5)
  v_mfma_f32_16x16x32_bf16 v[168:171], v[48:51], v[88:91], v[168:171]
  ds_read_b128 v[80:83], v102 offset:32768
  v_mfma_f32_16x16x32_bf16 v[172:175], v[52:55], v[88:91], v[172:175]
  s_waitcnt lgkmcnt(5)
  v_mfma_f32_16x16x32_bf16 v[168:171], v[56:59], v[92:95], v[168:171]
  ds_read_b128 v[84:87], v102 offset:40960
  v_mfma_f32_16x16x32_bf16 v[172:175], v[60:63], v[92:95], v[172:175]
  s_waitcnt lgkmcnt(5)
  v_mfma_f32_16x16x32_bf16 v[176:179], v[0:3], v[64:67], 0
  ds_read_b128 v[88:91], v102 offset:49152
  v_mfma_f32_16x16x32_bf16 v[180:183], v[4:7], v[64:67], 0
  s_waitcnt lgkmcnt(5)
  v_mfma_f32_16x16x32_bf16 v[176:179], v[8:11], v[68:71], v[176:179]
  ds_read_b128 v[92:95], v102 offset:57344
  v_mfma_f32_16x16x32_bf16 v[180:183], v[12:15], v[68:71], v[180:183]
  s_waitcnt lgkmcnt(5)
  v_mfma_f32_16x16x32_bf16 v[176:179], v[16:19], v[72:75], v[176:179]
  ds_read_b128 v[64:67], v103 offset:0
  v_mfma_f32_16x16x32_bf16 v[180:183], v[20:23], v[72:75], v[180:183]
  s_waitcnt lgkmcnt(5)
  v_mfma_f32_16x16x32_bf16 v[176:179], v[24:27], v[76:79], v[176:179]
  ds_read_b128 v[68:71], v103 offset:8192
  v_mfma_f32_16x16x32_bf16 v[180:183], v[28:31], v[76:79], v[180:183]
  s_waitcnt lgkmcnt(5)
  v_mfma_f32_16x16x32_bf16 v[176:179], v[32:35], v[80:83], v[176:179]
  ds_read_b128 v[72:75], v103 offset:16384
  v_mfma_f32_16x16x32_bf16 v[180:183], v[36:39], v[80:83], v[180:183]
  s_waitcnt lgkmcnt(5)
  v_mfma_f32_16x16x32_bf16 v[176:179], v[40:43], v[84:87], v[176:179]
  ds_read_b128 v[76:79], v103 offset:24576
  v_mfma_f32_16x16x32_bf16 v[180:183], v[44:47], v[84:87], v[180:183]
  s_waitcnt lgkmcnt(5)
  v_mfma_f32_16x16x32_bf16 v[176:179], v[48:51], v[88:91], v[176:179]
  ds_read_b128 v[80:83], v103 offset:32768
  v_mfma_f32_16x16x32_bf16 v[180:183], v[52:55], v[88:91], v[180:183]
  s_waitcnt lgkmcnt(5)
  v_mfma_f32_16x16x32_bf16 v[176:179], v[56:59], v[92:95], v[176:179]
  ds_read_b128 v[84:87], v103 offset:40960
  v_mfma_f32_16x16x32_bf16 v[180:183], v[60:63], v[92:95], v[180:183]
  s_waitcnt lgkmcnt(5)
  v_mfma_f32_16x16x32_bf16 v[184:187], v[0:3], v[64:67], 0
  ds_read_b128 v[88:91], v103 offset:49152
  v_mfma_f32_16x16x32_bf16 v[188:191], v[4:7], v[64:67], 0
  s_waitcnt lgkmcnt(5)
  v_mfma_f32_16x16x32_bf16 v[184:187], v[8:11], v[68:71], v[184:187]
  ds_read_b128 v[92:95], v103 offset:57344
  v_mfma_f32_16x16x32_bf16 v[188:191], v[12:15], v[68:71], v[188:191]
  s_waitcnt lgkmcnt(5)
  v_mfma_f32_16x16x32_bf16 v[184:187], v[16:19], v[72:75], v[184:187]
  v_mfma_f32_16x16x32_bf16 v[188:191], v[20:23], v[72:75], v[188:191]
  s_waitcnt lgkmcnt(4)
  v_mfma_f32_16x16x32_bf16 v[184:187], v[24:27], v[76:79], v[184:187]
  v_mfma_f32_16x16x32_bf16 v[188:191], v[28:31], v[76:79], v[188:191]
  s_waitcnt lgkmcnt(3)
  v_mfma_f32_16x16x32_bf16 v[184:187], v[32:35], v[80:83], v[184:187]
  v_mfma_f32_16x16x32_bf16 v[188:191], v[36:39], v[80:83], v[188:191]
  s_waitcnt lgkmcnt(2)
  v_mfma_f32_16x16x32_bf16 v[184:187], v[40:43], v[84:87], v[184:187]
  v_mfma_f32_16x16x32_bf16 v[188:191], v[44:47], v[84:87], v[188:191]
  s_waitcnt lgkmcnt(1)
  v_mfma_f32_16x16x32_bf16 v[184:187], v[48:51], v[88:91], v[184:187]
  v_mfma_f32_16x16x32_bf16 v[188:191], v[52:55], v[88:91], v[188:191]
  s_waitcnt lgkmcnt(0)
  v_mfma_f32_16x16x32_bf16 v[184:187], v[56:59], v[92:95], v[184:187]
  v_mfma_f32_16x16x32_bf16 v[188:191], v[60:63], v[92:95], v[188:191]
  s_cmp_lt_u32 s41, 3
  s_cselect_b32 s14, 0x4000000, 0
  v_xor_b32 v104, 64, v245
  v_xor_b32 v105, 64, v246
  s_add_u32 m0, s43, 0x0
  s_nop 0
  buffer_load_dwordx4 v246, s[12:15], s36 offen offset:0 nt lds
  s_add_u32 m0, s43, 0xfffffc00
  s_nop 0
  buffer_load_dwordx4 v105, s[12:15], s36 offen offset:2048 nt lds
  s_add_u32 m0, s43, 0x800
  s_nop 0
  buffer_load_dwordx4 v246, s[12:15], s37 offen offset:0 nt lds
  s_add_u32 m0, s43, 0x400
  s_nop 0
  buffer_load_dwordx4 v105, s[12:15], s37 offen offset:2048 nt lds
  s_waitcnt vmcnt(0)
  ds_read_b128 v[192:195], v245 offset:0
  ds_read_b128 v[196:199], v245 offset:2048
  ds_read_b128 v[200:203], v104 offset:0
  ds_read_b128 v[204:207], v104 offset:2048
  s_waitcnt lgkmcnt(0)
  v_xor_b32 v105, 64, v246
  s_add_u32 m0, s43, 0xffffff80
  s_nop 0
  buffer_load_dwordx4 v246, s[12:15], s36 offen offset:128 nt lds
  s_add_u32 m0, s43, 0xfffffb80
  s_nop 0
  buffer_load_dwordx4 v105, s[12:15], s36 offen offset:2176 nt lds
  s_add_u32 m0, s43, 0x780
  s_nop 0
  buffer_load_dwordx4 v246, s[12:15], s37 offen offset:128 nt lds
  s_add_u32 m0, s43, 0x380
  s_nop 0
  buffer_load_dwordx4 v105, s[12:15], s37 offen offset:2176 nt lds
  s_waitcnt vmcnt(0)
  ds_read_b128 v[208:211], v245 offset:0
  ds_read_b128 v[212:215], v245 offset:2048
  ds_read_b128 v[216:219], v104 offset:0
  ds_read_b128 v[220:223], v104 offset:2048
  s_waitcnt lgkmcnt(0)
  s_cmp_lt_u32 s41, 2
  s_cselect_b32 s14, 0x4000000, 0
  v_xor_b32 v105, 64, v246
  s_add_u32 m0, s43, 0x0
  s_nop 0
  buffer_load_dwordx4 v246, s[12:15], s39 offen offset:0 nt lds
  s_add_u32 m0, s43, 0xfffffc00
  s_nop 0
  buffer_load_dwordx4 v105, s[12:15], s39 offen offset:2048 nt lds
  s_add_u32 m0, s43, 0x800
  s_nop 0
  buffer_load_dwordx4 v246, s[12:15], s40 offen offset:0 nt lds
  s_add_u32 m0, s43, 0x400
  s_nop 0
  buffer_load_dwordx4 v105, s[12:15], s40 offen offset:2048 nt lds
  v_xor_b32 v120, 64, v244
  v_xor_b32 v121, 128, v244
  v_xor_b32 v122, 192, v244
  ds_read_b128 v[224:227], v244 offset:0
  ds_read_b128 v[228:231], v120 offset:0
  ds_read_b128 v[232:235], v121 offset:0
  ds_read_b128 v[236:239], v122 offset:0
  s_waitcnt vmcnt(0) lgkmcnt(0)
  s_nop 15
  s_branch L_fb_ret
  s_endpgm

.section .rodata,"a"
.p2align 6
.amdhsa_kernel standalone__gqa_softmax__near_ridge_kernel
  .amdhsa_next_free_vgpr 256
  .amdhsa_next_free_sgpr 102
  .amdhsa_accum_offset 256
  .amdhsa_group_segment_fixed_size 0
  .amdhsa_kernarg_size 48
  .amdhsa_user_sgpr_count 2
  .amdhsa_user_sgpr_kernarg_segment_ptr 1
  .amdhsa_system_sgpr_workgroup_id_x 1
.end_amdhsa_kernel
```
